```python
import torch

def _softmax(x, axis=-1):
    return torch.softmax(x, dim=axis)
def _gelu(x):
    return torch.nn.functional.gelu(x, approximate="tanh")
def _silu(x):
    return torch.nn.functional.silu(x)
def _sigmoid(x):
    return torch.sigmoid(x)
def _layernorm(x, axis=-1, eps=1e-5):
    m = x.mean(dim=axis, keepdim=True)
    v = x.var(dim=axis, keepdim=True, unbiased=False)
    return (x - m) / torch.sqrt(v + eps)
def _scatter_add(tgt, idx, src, axis=0):
    return tgt.clone().index_add_(axis, idx, src)
def _segment_sum(src, seg, n):
    out = torch.zeros((n,) + src.shape[1:], dtype=src.dtype)
    return out.index_add_(0, seg, src)
def _pad(x, pw):
    flat = tuple(v for pair in reversed(pw) for v in pair)
    return torch.nn.functional.pad(x, flat)

kernel_name = 'recurrent_scan__ssm_conv_h3__swiglu_ffn__prompt'

def setup_inputs():

    _w = (lambda a: (lambda t: t.to(torch.bfloat16) if t.is_floating_point() else t)(torch.as_tensor(a)))
    def _A_setup():
        B, S, D = 1, 2048, 512
        ks = 4
        return {
            "q": _w((lambda *s: torch.randn(*s, dtype=torch.bfloat16) * 0.05)(B, S, D)),
            "k": _w((lambda *s: torch.randn(*s, dtype=torch.bfloat16) * 0.2)(B, S, D)),
            "v": _w((lambda *s: torch.randn(*s, dtype=torch.bfloat16) * 0.2)(B, S, D)),
            "shift_k": _w((lambda *s: torch.randn(*s, dtype=torch.bfloat16) * 0.2)(D, ks) * 0.5),
            "ssm_k": _w((lambda *s: torch.randn(*s, dtype=torch.bfloat16) * 0.2)(D, S) * (1.0 / S ** 0.5)),
            "ssm_D": _w((lambda *s: torch.randn(*s, dtype=torch.bfloat16) * 0.2)(D)),
        }
    _A_in = _A_setup()

    def _B_setup():
        B, S, D, F = 1, 2048, 512, 1792
        return {
            "x": _w((lambda *s: torch.randn(*s, dtype=torch.bfloat16) * 0.05)(B, S, D)),
            "w_gate": _w((lambda *s: torch.randn(*s, dtype=torch.bfloat16) * 0.1)(D, F)),
            "w_up": _w((lambda *s: torch.randn(*s, dtype=torch.bfloat16) * 0.1)(D, F)),
            "w_down": _w((lambda *s: torch.randn(*s, dtype=torch.bfloat16) * 0.1)(F, D)),
        }
    _B_in = _B_setup()

    return {
        "A_q": _A_in["q"],
        "A_k": _A_in["k"],
        "A_v": _A_in["v"],
        "A_shift_k": _A_in["shift_k"],
        "A_ssm_k": _A_in["ssm_k"],
        "A_ssm_D": _A_in["ssm_D"],
        "B_x": _B_in["x"],
        "B_w_gate": _B_in["w_gate"],
        "B_w_up": _B_in["w_up"],
        "B_w_down": _B_in["w_down"],
    }

def reference(A_q, A_k, A_v, A_shift_k, A_ssm_k, A_ssm_D, B_x, B_w_gate, B_w_up, B_w_down):
    def _A_ref(q, k, v, shift_k, ssm_k, ssm_D):
        B, S, D = q.shape
        ks = shift_k.shape[-1]
        k_pad = _pad(k, ((0, 0), (ks - 1, 0), (0, 0)))
        k_shift = torch.zeros_like(k)
        for t in range(ks):
            k_shift = k_shift + k_pad[:, t:t + S, :] * shift_k[:, ks - 1 - t][None, None, :]
        kv = k_shift * v
        L = 2 * S
        kv_pad = _pad(kv, ((0, 0), (0, S), (0, 0)))
        kf_pad = _pad(ssm_k, ((0, 0), (0, S)))
        kv_f = (lambda x, axes=(-2,-1): torch.fft.rfft2(x.float(), dim=axes))(kv_pad[:, None, :, :], axes=(1, 2))
        kf_f = (lambda x, axes=(-2,-1): torch.fft.rfft2(x.float(), dim=axes))(kf_pad[:, None, :], axes=(1, 2))
        kf_f = (lambda x, *d: x.permute(*d))(kf_f, 1, 2, 0)
        y_f = kv_f * kf_f[None, :, :, :]
        y = (lambda x, s, axes=(-2,-1): torch.fft.irfft2(x, s=s, dim=axes).to(torch.bfloat16))(y_f, (1, L), axes=(1, 2))[:, 0, :S, :]
        y = y + kv * ssm_D[None, None, :]
        return q * y

    def _B_ref(x, w_gate, w_up, w_down):
        g = _silu(x @ w_gate)
        u = x @ w_up
        return (g * u) @ w_down

    x = A_q
    xn = _layernorm(x, axis=-1)
    s = _A_ref(xn, A_k, A_v, A_shift_k, A_ssm_k, A_ssm_D)
    g = _silu(_B_ref(xn, B_w_gate, B_w_up, B_w_down))
    return x + s * g
```

```asm
; @launch grid=(256,1,1) block=(256,1,1) lds=163840
.amdgcn_target "amdgcn-amd-amdhsa--gfx950"
.text

.globl recurrent_scan__ssm_conv_h3__swiglu_ffn__prompt_kernel
.p2align 8
.type recurrent_scan__ssm_conv_h3__swiglu_ffn__prompt_kernel,@function
recurrent_scan__ssm_conv_h3__swiglu_ffn__prompt_kernel:

s_load_dwordx8 s[80:87], s[0:1], 0
s_load_dwordx16 s[60:75], s[0:1], 32
s_load_dwordx2 s[76:77], s[0:1], 96
s_cmp_ge_u32 s2, 256
s_cbranch_scc1 L_end
s_cmp_ge_u32 s2, 32
s_cbranch_scc1 L_gemm
s_getpc_b64 s[4:5]
v_lshlrev_b32 v1, 7, v0
s_and_b32 s4, s4, 0xffffff00
v_min_u32 v1, L_code_end-recurrent_scan__ssm_conv_h3__swiglu_ffn__prompt_kernel-128, v1
global_load_dword v200, v1, s[4:5]
s_branch L_aux
L_gemm:
  v_and_b32 v1, 63, v0
  v_lshrrev_b32 v2, 6, v0
  v_lshlrev_b32 v31, 4, v1
  v_readfirstlane_b32 s20, v2
  v_lshrrev_b32 v2, 3, v1
  v_and_b32 v3, 7, v1
  v_lshrrev_b32 v9, 4, v1
  v_mov_b32 v34, 0
  s_sub_u32 s3, s2, 32
  s_and_b32 s4, s3, 7
  s_lshr_b32 s5, s3, 3
  s_and_b32 s6, s4, 1
  s_and_b32 s7, s5, 3
  s_lshl_b32 s34, s7, 1
  s_add_u32 s34, s34, s6
  s_lshl_b32 s6, s6, 2
  s_add_u32 s21, s6, s7
  s_lshr_b32 s6, s4, 1
  s_mul_i32 s6, s6, 7
  s_lshr_b32 s7, s5, 2
  s_add_u32 s22, s6, s7
  s_lshr_b32 s6, s4, 1
  s_xor_b32 s34, s6, s21
  v_xor_b32 v5, v9, v3
  v_lshlrev_b32 v5, 4, v5
  v_lshl_add_u32 v14, v2, 10, v5
  v_xor_b32 v5, 64, v14
  v_add_u32 v15, 7168, v5
  v_add_u32 v16, 14336, v14
  v_add_u32 v17, 21504, v5
  s_lshr_b32 s3, s20, 1
  s_lshl_b32 s3, s3, 2
  v_and_b32 v5, 1, v9
  v_lshlrev_b32 v5, 1, v5
  v_xor_b32 v5, s3, v5
  v_xor_b32 v5, v5, v3
  v_lshlrev_b32 v5, 4, v5
  s_and_b32 s4, s20, 1
  s_mul_i32 s4, s4, 114688
  s_lshl_b32 s5, s22, 7
  s_add_u32 s4, s4, s5
  v_mul_u32_u24 v6, 3584, v2
  v_add3_u32 v10, v5, v6, s4
  v_add_u32 v11, 27648, v10
  v_add_u32 v12, 55296, v10
  v_add_u32 v13, 82944, v10
  s_lshl_b32 s35, s21, 18
  s_lshl_b32 s5, s20, 15
  s_add_u32 s7, s35, s5
  s_lshl_b32 s24, s20, 12
  s_add_u32 s23, s24, 16384
  s_mul_i32 s88, s34, 229376
  s_lshl_b32 s3, s34, 7
  s_add_u32 s92, s3, s7
  s_waitcnt lgkmcnt(0)
  s_mov_b32 s8, s80
  s_and_b32 s9, s81, 0xffff
  s_mov_b32 s10, 0x200000
  s_mov_b32 s11, 0x20000
  s_cmp_ge_u32 s20, 2
  s_cselect_b32 s66, s68, s66
  s_cselect_b32 s67, s69, s67
  s_mov_b32 s12, s66
  s_and_b32 s13, s67, 0xffff
  s_mov_b32 s14, 0x1c0000
  s_mov_b32 s15, 0x20000
  s_add_u32 m0, s24, 0
  s_nop 0
  buffer_load_dwordx4 v10, s[12:15], s88 offen offset:0 lds
  buffer_load_dwordx4 v11, s[12:15], s88 offen offset:1024 lds
  buffer_load_dwordx4 v12, s[12:15], s88 offen offset:2048 lds
  buffer_load_dwordx4 v13, s[12:15], s88 offen offset:3072 lds
  s_add_u32 m0, s23, 0
  s_nop 0
  buffer_load_dwordx4 v14, s[8:11], s92 offen offset:0 lds
  buffer_load_dwordx4 v15, s[8:11], s92 offen offset:1024 lds
  buffer_load_dwordx4 v16, s[8:11], s92 offen offset:2048 lds
  buffer_load_dwordx4 v17, s[8:11], s92 offen offset:3072 lds
  s_mov_b32 s27, s7
  s_mov_b32 s16, s76
  s_and_b32 s17, s77, 0xffff
  s_mov_b32 s18, 0xc00000
  s_mov_b32 s19, 0x20000
  s_mov_b32 s32, s74
  s_mov_b32 s33, s75
  s_lshr_b32 s3, s2, 3
  s_lshl_b32 s3, s3, 16
  s_and_b32 s4, s2, 7
  s_lshl_b32 s5, s4, 7
  s_add_u32 s5, s5, s3
  v_lshrrev_b32 v9, 3, v1
  v_and_b32 v38, 7, v1
  v_lshlrev_b32 v2, 4, v38
  v_lshl_add_u32 v2, v9, 10, v2
  s_add_u32 s6, s5, 57344
  v_add_u32 v4, s6, v2
  s_lshl_b32 s6, s20, 14
  s_add_u32 s5, s5, s6
  v_add_u32 v3, s5, v2
  v_add_u32 v2, 0xffffe000, v3
  v_add_u32 v5, 7136, v3
  s_lshl_b32 s6, s20, 5
  s_add_u32 s6, s6, 141312
  v_mul_u32_u24 v36, 1056, v9
  v_lshl_add_u32 v36, v38, 2, v36
  v_add_u32 v36, s6, v36
  s_lshl_b32 s6, s4, 18
  s_lshl_b32 s7, s20, 16
  s_add_u32 s6, s6, s7
  s_lshr_b32 s7, s3, 9
  s_sub_u32 s6, s6, s7
  s_add_u32 s6, s6, 7344112
  v_lshlrev_b32 v37, 13, v38
  v_lshlrev_b32 v9, 4, v9
  v_sub_u32 v37, v37, v9
  v_add_u32 v37, s6, v37
  s_lshl_b32 s6, s4, 9
  s_lshl_b32 s7, s20, 7
  s_add_u32 s6, s6, s7
  v_lshl_add_u32 v38, v38, 4, s6
  s_lshl_b32 s6, s2, 7
  s_lshl_b32 s7, s20, 3
  s_add_u32 s6, s6, s7
  s_add_u32 s30, s6, 11567104
  s_mov_b32 s36, s82
  s_and_b32 s37, s83, 0xffff
  s_mov_b32 s38, 0x200000
  s_mov_b32 s39, 0x20000
  s_mov_b32 s44, s84
  s_and_b32 s45, s85, 0xffff
  s_mov_b32 s46, 0x200000
  s_mov_b32 s47, 0x20000
  s_mov_b32 s64, s86
  s_and_b32 s65, s87, 0xffff
  s_mov_b32 s66, 0x1000
  s_mov_b32 s67, 0x20000
  s_lshr_b32 s3, s20, 1
  s_lshl_b32 s4, s2, 1
  s_add_u32 s4, s4, s3
  s_mul_i32 s55, s3, 12928
  s_add_u32 s55, s55, 98304
  s_and_b32 s74, s20, 1
  s_lshl_b32 s75, s4, 12
  s_lshl_b32 s31, s4, 1
  s_lshl_b32 s77, s20, 12
  v_bfe_u32 v40, v1, 4, 1
  v_and_b32 v41, 15, v1
  v_add_u32 v42, v40, v41
  v_add_u32 v42, -16, v42
  v_lshlrev_b32 v248, 1, v42
  s_add_u32 s40, s60, s75
  s_addc_u32 s41, s61, 0
  s_and_b32 s41, s41, 0xffff
  s_sub_u32 s42, 0x200000, s75
  s_mov_b32 s43, 0x20000
  s_mov_b32 s80, s62
  s_and_b32 s81, s63, 0xffff
  s_mov_b32 s82, 0x400
  s_mov_b32 s83, 0x20000
  s_xor_b32 s3, s34, 1
  s_mul_i32 s85, s3, 229376
  s_lshl_b32 s3, s3, 7
  s_add_u32 s93, s3, s27
  s_xor_b32 s3, s34, 2
  s_mul_i32 s86, s3, 229376
  s_lshl_b32 s3, s3, 7
  s_add_u32 s94, s3, s27
  s_xor_b32 s3, s34, 3
  s_mul_i32 s87, s3, 229376
  s_lshl_b32 s3, s3, 7
  s_add_u32 s95, s3, s27
  s_xor_b32 s3, s34, 4
  s_mul_i32 s88, s3, 229376
  s_lshl_b32 s3, s3, 7
  s_add_u32 s96, s3, s27
  s_xor_b32 s3, s34, 5
  s_mul_i32 s89, s3, 229376
  s_lshl_b32 s3, s3, 7
  s_add_u32 s97, s3, s27
  s_xor_b32 s3, s34, 6
  s_mul_i32 s90, s3, 229376
  s_lshl_b32 s3, s3, 7
  s_add_u32 s98, s3, s27
  s_xor_b32 s3, s34, 7
  s_mul_i32 s91, s3, 229376
  s_lshl_b32 s3, s3, 7
  s_add_u32 s99, s3, s27
  s_lshl_b32 s25, s20, 13
  s_add_u32 s6, s35, 131072
  s_lshl_b32 s3, s20, 1
  s_add_u32 s3, s3, 0
  s_xor_b32 s3, s3, s34
  s_lshl_b32 s3, s3, 7
  s_add_u32 s50, s3, s6
  s_lshl_b32 s3, s20, 1
  s_add_u32 s3, s3, 1
  s_xor_b32 s3, s3, s34
  s_lshl_b32 s3, s3, 7
  s_add_u32 s51, s3, s6
  s_lshl_b32 s3, s22, 2
  s_add_u32 s3, s3, s20
  s_lshl_b32 s3, s3, 10
  s_mul_i32 s4, s21, 917504
  s_add_u32 s28, s3, s4
  s_lshl_b32 s4, s21, 12
  s_add_u32 s29, s4, 11534336
  v_and_b32 v40, 31, v1
  v_lshrrev_b32 v41, 5, v1
  v_lshlrev_b32 v29, 4, v40
  s_lshl_b32 s3, s21, 5
  s_add_u32 s3, s3, s22
  s_lshl_b32 s3, s3, 7
  s_add_u32 s58, s3, 11599872
  v_bfe_u32 v42, v1, 1, 3
  v_xor_b32 v42, v42, v41
  v_lshlrev_b32 v42, 4, v42
  v_lshl_add_u32 v18, v40, 7, v42
  v_xor_b32 v19, 32, v18
  v_xor_b32 v20, 64, v18
  v_xor_b32 v21, 96, v18
  v_add_u32 v22, 0x10000, v18
  v_add_u32 v23, 0x10000, v19
  v_add_u32 v24, 0x10000, v20
  v_add_u32 v25, 0x10000, v21
  v_bfe_u32 v40, v1, 2, 2
  v_bfe_u32 v42, v1, 1, 1
  v_and_b32 v43, 1, v1
  v_bfe_u32 v44, v1, 4, 1
  v_lshrrev_b32 v45, 1, v40
  v_lshl_add_u32 v45, v42, 1, v45
  v_xor_b32 v45, s20, v45
  v_lshlrev_b32 v45, 5, v45
  v_lshl_add_u32 v45, v43, 4, v45
  v_lshl_add_u32 v45, v44, 3, v45
  v_lshl_add_u32 v45, v42, 13, v45
  v_lshl_add_u32 v40, v41, 3, v40
  v_lshl_add_u32 v26, v40, 7, v45
  v_add_u32 v27, 0x10000, v26
  v_mov_b32 v180, 0x3f803f80
  v_mov_b32 v181, 0x3f803f80
  s_add_u32 m0, s24, 32768
  s_nop 0
  buffer_load_dwordx4 v10, s[12:15], s85 offen offset:0 lds
  buffer_load_dwordx4 v11, s[12:15], s85 offen offset:1024 lds
  buffer_load_dwordx4 v12, s[12:15], s85 offen offset:2048 lds
  buffer_load_dwordx4 v13, s[12:15], s85 offen offset:3072 lds
  s_add_u32 m0, s23, 32768
  s_nop 0
  buffer_load_dwordx4 v14, s[8:11], s93 offen offset:0 lds
  buffer_load_dwordx4 v15, s[8:11], s93 offen offset:1024 lds
  buffer_load_dwordx4 v16, s[8:11], s93 offen offset:2048 lds
  buffer_load_dwordx4 v17, s[8:11], s93 offen offset:3072 lds
  s_mul_i32 s52, s20, 2112
  s_add_u32 s52, s52, 141312
  s_mov_b32 m0, s52
  s_nop 0
  buffer_load_dwordx4 v2, s[36:39], 0 offen offset:0 lds
  s_add_u32 m0, s52, 1056
  s_nop 0
  buffer_load_dwordx4 v3, s[36:39], 0 offen offset:0 lds
  s_mov_b32 m0, 149760
  s_nop 0
  buffer_load_dwordx4 v4, s[36:39], 0 offen offset:0 lds
  s_add_u32 m0, s52, 9504
  s_nop 0
  buffer_load_dwordx4 v3, s[44:47], 0 offen offset:0 lds
  buffer_load_dwordx4 v5, s[44:47], 0 offen offset:1056 lds
  buffer_load_dwordx4 v[72:75], v38, s[64:67], 0 offen
  s_waitcnt vmcnt(14)
  s_barrier
  ds_read_b64_tr_b16 a[0:1], v26 offset:0
  ds_read_b64_tr_b16 a[2:3], v26 offset:512
  ds_read_b128 v[84:87], v18 offset:16384
  ds_read_b128 v[88:91], v18 offset:20480
  ds_read_b128 v[92:95], v18 offset:24576
  ds_read_b128 v[96:99], v18 offset:28672
  s_waitcnt lgkmcnt(2)
  v_mfma_f32_4x4x4_16b_bf16 v[196:199], v[180:181], a[0:1], 0
  v_mfma_f32_32x32x16_bf16 v[116:131], a[0:3], v[84:87], 0
  ds_read_b64_tr_b16 a[4:5], v26 offset:2048
  ds_read_b64_tr_b16 a[6:7], v26 offset:2560
  s_add_u32 m0, s24, 65536
  s_and_b32 s3, s2, 7
  s_lshr_b32 s4, s2, 3
  s_lshl_b32 s3, s3, 2
  v_mfma_f32_4x4x4_16b_bf16 v[200:203], v[180:181], a[2:3], 0
  v_mfma_f32_32x32x16_bf16 v[132:147], a[0:3], v[88:91], 0
  ds_read_b128 v[100:103], v19 offset:16384
  ds_read_b128 v[104:107], v19 offset:20480
  buffer_load_dwordx4 v10, s[12:15], s86 offen offset:0 lds
  s_and_b32 s5, s4, 3
  s_add_u32 s53, s3, s5
  s_waitcnt lgkmcnt(4)
  v_mfma_f32_32x32x16_bf16 v[148:163], a[0:3], v[92:95], 0
  ds_read_b128 v[108:111], v19 offset:24576
  ds_read_b128 v[112:115], v19 offset:28672
  s_lshr_b32 s54, s4, 2
  s_xor_b32 s54, s54, 3
  v_lshrrev_b32 v40, 4, v1
  v_and_b32 v41, 15, v1
  v_mfma_f32_32x32x16_bf16 v[164:179], a[0:3], v[96:99], 0
  buffer_load_dwordx4 v11, s[12:15], s86 offen offset:1024 lds
  v_lshrrev_b32 v42, 3, v1
  v_and_b32 v43, 7, v1
  v_and_b32 v44, 1, v40
  v_lshlrev_b32 v44, 2, v44
  s_waitcnt lgkmcnt(2)
  v_mfma_f32_4x4x4_16b_bf16 v[196:199], v[180:181], a[4:5], v[196:199]
  v_mfma_f32_32x32x16_bf16 v[116:131], a[4:7], v[100:103], v[116:131]
  ds_read_b64_tr_b16 a[8:9], v26 offset:4096
  ds_read_b64_tr_b16 a[10:11], v26 offset:4608
  v_xor_b32 v44, v44, v43
  s_lshl_b32 s7, s54, 7
  s_mul_i32 s5, s20, 458752
  s_add_u32 s7, s7, s5
  v_mfma_f32_4x4x4_16b_bf16 v[200:203], v[180:181], a[6:7], v[200:203]
  v_mfma_f32_32x32x16_bf16 v[132:147], a[4:7], v[104:107], v[132:147]
  ds_read_b128 v[84:87], v20 offset:16384
  ds_read_b128 v[88:91], v20 offset:20480
  buffer_load_dwordx4 v12, s[12:15], s86 offen offset:2048 lds
  v_lshlrev_b32 v44, 4, v44
  v_lshl_add_u32 v44, v42, 10, v44
  s_waitcnt lgkmcnt(4)
  v_mfma_f32_32x32x16_bf16 v[148:163], a[4:7], v[108:111], v[148:163]
  ds_read_b128 v[92:95], v20 offset:24576
  ds_read_b128 v[96:99], v20 offset:28672
  v_add_u32 v228, s7, v44
  v_add_u32 v229, 7168, v228
  v_add_u32 v230, 14336, v228
  v_add_u32 v231, 21504, v228
  v_mfma_f32_32x32x16_bf16 v[164:179], a[4:7], v[112:115], v[164:179]
  buffer_load_dwordx4 v13, s[12:15], s86 offen offset:3072 lds
  s_add_u32 m0, s23, 65536
  s_lshr_b32 s5, s53, 2
  s_lshl_b32 s5, s5, 4
  s_and_b32 s6, s53, 3
  s_waitcnt lgkmcnt(2)
  v_mfma_f32_4x4x4_16b_bf16 v[196:199], v[180:181], a[8:9], v[196:199]
  v_mfma_f32_32x32x16_bf16 v[116:131], a[8:11], v[84:87], v[116:131]
  ds_read_b64_tr_b16 a[12:13], v26 offset:6144
  ds_read_b64_tr_b16 a[14:15], v26 offset:6656
  s_lshl_b32 s6, s6, 1
  s_add_u32 s6, s5, s6
  s_mul_i32 s5, s6, 57344
  s_mul_i32 s7, s20, 28672
  v_mfma_f32_4x4x4_16b_bf16 v[200:203], v[180:181], a[10:11], v[200:203]
  v_mfma_f32_32x32x16_bf16 v[132:147], a[8:11], v[88:91], v[132:147]
  ds_read_b128 v[100:103], v21 offset:16384
  ds_read_b128 v[104:107], v21 offset:20480
  buffer_load_dwordx4 v14, s[8:11], s94 offen offset:0 lds
  s_add_u32 s5, s5, s7
  v_add_u32 v232, s5, v31
  s_waitcnt lgkmcnt(4)
  v_mfma_f32_32x32x16_bf16 v[148:163], a[8:11], v[92:95], v[148:163]
  ds_read_b128 v[108:111], v21 offset:24576
  ds_read_b128 v[112:115], v21 offset:28672
  v_add_u32 v233, 458752, v232
  s_lshl_b32 s5, s6, 4
  s_lshl_b32 s7, s20, 3
  s_add_u32 s5, s5, s7
  v_mfma_f32_32x32x16_bf16 v[164:179], a[8:11], v[96:99], v[164:179]
  buffer_load_dwordx4 v15, s[8:11], s94 offen offset:1024 lds
  v_lshrrev_b32 v44, 5, v1
  v_and_b32 v45, 3, v1
  v_lshl_add_u32 v44, v44, 2, v45
  v_add_u32 v44, s5, v44
  s_waitcnt lgkmcnt(2)
  v_mfma_f32_4x4x4_16b_bf16 v[196:199], v[180:181], a[12:13], v[196:199]
  v_mfma_f32_32x32x16_bf16 v[116:131], a[12:15], v[100:103], v[116:131]
  v_bfe_u32 v45, v1, 2, 3
  v_lshlrev_b32 v45, 4, v45
  v_lshl_add_u32 v45, v44, 10, v45
  s_lshl_b32 s7, s54, 7
  v_add_u32 v244, s7, v45
  v_lshlrev_b32 v44, 4, v44
  v_add_u32 v245, 11534336, v44
  v_bfe_u32 v42, v1, 2, 2
  v_lshrrev_b32 v43, 5, v1
  v_lshl_add_u32 v43, v43, 3, v42
  v_lshlrev_b32 v43, 7, v43
  v_lshrrev_b32 v42, 1, v42
  v_lshl_add_u32 v43, v42, 6, v43
  v_and_b32 v42, 1, v40
  v_lshl_add_u32 v43, v42, 5, v43
  v_and_b32 v42, 3, v1
  v_lshl_add_u32 v43, v42, 3, v43
  v_add_u32 v236, s77, v43
  v_xor_b32 v237, 64, v236
  v_add_u32 v42, 1, v41
  v_and_b32 v43, 1, v42
  v_sub_u32 v42, v42, v43
  v_lshl_add_u32 v42, v40, 3, v42
  v_lshlrev_b32 v42, 1, v42
  v_mul_u32_u24 v43, 4160, v43
  s_lshl_b32 s7, s74, 8
  s_add_u32 s7, s7, s55
  v_add3_u32 v240, v42, v43, s7
  v_lshlrev_b32 v42, 5, v41
  v_lshlrev_b32 v43, 4, v40
  v_sub_u32 v42, v43, v42
  s_add_u32 s7, s7, 8800
  v_add_u32 v241, s7, v42
  v_and_b32 v42, 1, v40
  v_mul_u32_u24 v42, 4160, v42
  v_lshl_add_u32 v42, v41, 1, v42
  v_add_u32 v249, s55, v42
  v_mov_b32 v46, 0
  v_mov_b32 v47, 0
  v_lshlrev_b32 v42, 3, v1
  s_add_u32 s7, s55, 12416
  v_add_u32 v42, s7, v42
  ds_write_b64 v42, v[46:47]
  v_and_b32 v42, 2, v40
  v_lshlrev_b32 v42, 3, v42
  v_and_b32 v43, 1, v41
  v_lshl_add_u32 v42, v43, 5, v42
  v_bfe_u32 v43, v41, 1, 2
  v_lshl_add_u32 v42, v43, 7, v42
  v_lshrrev_b32 v43, 3, v41
  v_lshl_add_u32 v42, v43, 6, v42
  v_and_b32 v43, 1, v40
  v_lshl_add_u32 v242, v43, 9, v42
  s_lshl_b32 s7, s74, 11
  s_add_u32 s7, s7, s75
  s_add_u32 s57, s7, 9437184
  s_lshl_b32 s7, s2, 13
  s_lshl_b32 s3, s20, 10
  s_add_u32 s7, s7, s3
  s_add_u32 s56, s7, 7340032
  s_waitcnt vmcnt(12) lgkmcnt(0)
  s_barrier
  ds_read_b64_tr_b16 a[16:17], v26 offset:32768
  ds_read_b64_tr_b16 a[18:19], v26 offset:33280
  s_lshl_b32 s7, s2, 7
  s_add_u32 s59, s7, 11632640
  v_mfma_f32_4x4x4_16b_bf16 v[200:203], v[180:181], a[14:15], v[200:203]
  v_mfma_f32_32x32x16_bf16 v[132:147], a[12:15], v[104:107], v[132:147]
  ds_read_b128 v[84:87], v18 offset:49152
  ds_read_b128 v[88:91], v18 offset:53248
  buffer_load_dwordx4 v16, s[8:11], s94 offen offset:2048 lds
  v_and_b32 v42, 7, v1
  v_lshlrev_b32 v42, 7, v42
  v_mfma_f32_32x32x16_bf16 v[148:163], a[12:15], v[108:111], v[148:163]
  ds_read_b128 v[92:95], v18 offset:57344
  ds_read_b128 v[96:99], v18 offset:61440
  buffer_load_dwordx4 v17, s[8:11], s94 offen offset:3072 lds
  global_load_dwordx2 v[32:33], v34, s[32:33] sc1
  s_add_u32 m0, s24, 0
  s_lshl_b32 s7, s54, 12
  v_mfma_f32_32x32x16_bf16 v[164:179], a[12:15], v[112:115], v[164:179]
  s_lshl_b32 s3, s20, 10
  s_add_u32 s7, s7, s3
  s_add_u32 s7, s7, 11632640
  v_add_u32 v243, s7, v42
  v_min_u32 v42, 6, v1
  s_waitcnt lgkmcnt(2)
  v_mfma_f32_4x4x4_16b_bf16 v[196:199], v[180:181], a[16:17], v[196:199]
  v_mfma_f32_32x32x16_bf16 v[116:131], a[16:19], v[84:87], v[116:131]
  ds_read_b64_tr_b16 a[20:21], v26 offset:34816
  ds_read_b64_tr_b16 a[22:23], v26 offset:35328
  buffer_load_dwordx4 v10, s[12:15], s87 offen offset:0 lds
  v_lshlrev_b32 v42, 7, v42
  s_lshr_b32 s7, s53, 2
  s_lshl_b32 s7, s7, 5
  v_mfma_f32_4x4x4_16b_bf16 v[200:203], v[180:181], a[18:19], v[200:203]
  v_mfma_f32_32x32x16_bf16 v[132:147], a[16:19], v[88:91], v[132:147]
  ds_read_b128 v[100:103], v19 offset:49152
  ds_read_b128 v[104:107], v19 offset:53248
  s_mul_i32 s3, s20, 7
  s_add_u32 s7, s7, s3
  s_lshl_b32 s7, s7, 7
  s_waitcnt lgkmcnt(4)
  v_mfma_f32_32x32x16_bf16 v[148:163], a[16:19], v[92:95], v[148:163]
  ds_read_b128 v[108:111], v19 offset:57344
  ds_read_b128 v[112:115], v19 offset:61440
  buffer_load_dwordx4 v11, s[12:15], s87 offen offset:1024 lds
  s_add_u32 s7, s7, 11599872
  v_add_u32 v246, s7, v42
  v_and_b32 v42, 7, v1
  v_mfma_f32_32x32x16_bf16 v[164:179], a[16:19], v[96:99], v[164:179]
  v_lshlrev_b32 v42, 10, v42
  s_lshr_b32 s7, s2, 5
  s_lshl_b32 s7, s7, 7
  s_and_b32 s3, s2, 24
  s_add_u32 s7, s7, s3
  s_waitcnt lgkmcnt(2)
  v_mfma_f32_4x4x4_16b_bf16 v[196:199], v[180:181], a[20:21], v[196:199]
  v_mfma_f32_32x32x16_bf16 v[116:131], a[20:23], v[100:103], v[116:131]
  ds_read_b64_tr_b16 a[24:25], v26 offset:36864
  ds_read_b64_tr_b16 a[26:27], v26 offset:37376
  buffer_load_dwordx4 v12, s[12:15], s87 offen offset:2048 lds
  s_lshl_b32 s3, s20, 13
  s_sub_u32 s7, s7, s3
  s_add_u32 s7, s7, 11598848
  v_mfma_f32_4x4x4_16b_bf16 v[200:203], v[180:181], a[22:23], v[200:203]
  v_mfma_f32_32x32x16_bf16 v[132:147], a[20:23], v[104:107], v[132:147]
  ds_read_b128 v[84:87], v20 offset:49152
  ds_read_b128 v[88:91], v20 offset:53248
  v_sub_u32 v247, s7, v42
  s_waitcnt lgkmcnt(4)
  v_mfma_f32_32x32x16_bf16 v[148:163], a[20:23], v[108:111], v[148:163]
  ds_read_b128 v[92:95], v20 offset:57344
  ds_read_b128 v[96:99], v20 offset:61440
  buffer_load_dwordx4 v13, s[12:15], s87 offen offset:3072 lds
  s_add_u32 m0, s23, 0
  v_mfma_f32_32x32x16_bf16 v[164:179], a[20:23], v[112:115], v[164:179]
  v_cmp_ne_u32 vcc, 0, v1
  v_mov_b32 v42, 0x80000000
  v_mov_b32 v43, 0
  v_cndmask_b32 v8, v43, v42, vcc
  v_lshrrev_b32 v186, 5, v1
  s_waitcnt lgkmcnt(2)
  v_mfma_f32_4x4x4_16b_bf16 v[196:199], v[180:181], a[24:25], v[196:199]
  v_mfma_f32_32x32x16_bf16 v[116:131], a[24:27], v[84:87], v[116:131]
  ds_read_b64_tr_b16 a[28:29], v26 offset:38912
  ds_read_b64_tr_b16 a[30:31], v26 offset:39424
  buffer_load_dwordx4 v14, s[8:11], s95 offen offset:0 lds
  v_add_u32 v186, -1, v186
  v_mov_b32 v41, 0
  v_mov_b32 v42, 0
  v_mfma_f32_4x4x4_16b_bf16 v[200:203], v[180:181], a[26:27], v[200:203]
  v_mfma_f32_32x32x16_bf16 v[132:147], a[24:27], v[88:91], v[132:147]
  ds_read_b128 v[100:103], v21 offset:49152
  ds_read_b128 v[104:107], v21 offset:53248
  v_mov_b32 v43, 0
  v_mov_b32 v45, 0
  v_mov_b32 v46, 0
  s_waitcnt lgkmcnt(4)
  v_mfma_f32_32x32x16_bf16 v[148:163], a[24:27], v[92:95], v[148:163]
  ds_read_b128 v[108:111], v21 offset:57344
  ds_read_b128 v[112:115], v21 offset:61440
  buffer_load_dwordx4 v15, s[8:11], s95 offen offset:1024 lds
  v_mov_b32 v47, 0
  v_mov_b32 v49, 0
  v_mov_b32 v50, 0
  v_mfma_f32_32x32x16_bf16 v[164:179], a[24:27], v[96:99], v[164:179]
  buffer_load_dwordx4 v16, s[8:11], s95 offen offset:2048 lds
  v_mov_b32 v51, 0
  s_mov_b32 s36, s70
  s_and_b32 s37, s71, 0xffff
  s_mov_b32 s38, 0x1c0000
  s_waitcnt lgkmcnt(2)
  v_mfma_f32_4x4x4_16b_bf16 v[196:199], v[180:181], a[28:29], v[196:199]
  v_mfma_f32_32x32x16_bf16 v[116:131], a[28:31], v[100:103], v[116:131]
  s_mov_b32 s39, 0x20000
  s_mov_b32 s44, s72
  s_and_b32 s45, s73, 0xffff
  s_mov_b32 s46, 0x200000
  s_mov_b32 s47, 0x20000
  s_mov_b32 s60, 0
  s_mov_b32 s61, 32768
  s_mov_b32 s62, 65536
  s_mov_b32 s63, 98304
  s_mov_b32 s64, 131072
  s_mov_b32 s65, 163840
  s_mov_b32 s66, 196608
  s_mov_b32 s67, 229376
  s_mov_b32 s68, 262144
  s_mov_b32 s69, 294912
  s_mov_b32 s70, 327680
  s_mov_b32 s71, 360448
  s_mov_b32 s72, 393216
  s_mov_b32 s73, 425984
  s_waitcnt vmcnt(8) lgkmcnt(0)
  s_barrier
  ds_read_b64_tr_b16 a[32:33], v27 offset:0
  ds_read_b64_tr_b16 a[34:35], v27 offset:512
  buffer_load_dwordx4 v17, s[8:11], s95 offen offset:3072 lds
  v_mfma_f32_4x4x4_16b_bf16 v[200:203], v[180:181], a[30:31], v[200:203]
  v_mfma_f32_32x32x16_bf16 v[132:147], a[28:31], v[104:107], v[132:147]
  ds_read_b128 v[84:87], v22 offset:16384
  ds_read_b128 v[88:91], v22 offset:20480
  s_add_u32 m0, s24, 32768
  s_waitcnt vmcnt(8)
  v_readfirstlane_b32 s48, v32
  v_mfma_f32_32x32x16_bf16 v[148:163], a[28:31], v[108:111], v[148:163]
  ds_read_b128 v[92:95], v22 offset:24576
  ds_read_b128 v[96:99], v22 offset:28672
  buffer_load_dwordx4 v10, s[12:15], s88 offen offset:0 lds
  v_readfirstlane_b32 s49, v33
  s_cmp_lg_u32 s48, 0
  s_cbranch_scc0 L_slow_ng
L_ok_ng:
  v_mfma_f32_32x32x16_bf16 v[164:179], a[28:31], v[112:115], v[164:179]
  v_mov_b32 v6, v32
  v_mov_b32 v7, v33
  ds_read_b32 v52, v36 offset:640
  ds_read_b32 v53, v36 offset:768
  ds_read_b32 v54, v36 offset:896
  s_waitcnt lgkmcnt(5)
  v_mfma_f32_4x4x4_16b_bf16 v[196:199], v[180:181], a[32:33], v[196:199]
  v_mfma_f32_32x32x16_bf16 v[116:131], a[32:35], v[84:87], v[116:131]
  ds_read_b64_tr_b16 a[36:37], v27 offset:2048
  ds_read_b64_tr_b16 a[38:39], v27 offset:2560
  buffer_load_dwordx4 v11, s[12:15], s88 offen offset:1024 lds
  ds_read_b32 v55, v36 offset:1056
  ds_read_b32 v56, v36 offset:1184
  ds_read_b32 v57, v36 offset:1312
  v_mfma_f32_4x4x4_16b_bf16 v[200:203], v[180:181], a[34:35], v[200:203]
  v_mfma_f32_32x32x16_bf16 v[132:147], a[32:35], v[88:91], v[132:147]
  ds_read_b128 v[100:103], v23 offset:16384
  ds_read_b128 v[104:107], v23 offset:20480
  ds_read_b32 v58, v36 offset:1440
  ds_read_b32 v59, v36 offset:1568
  ds_read_b32 v60, v36 offset:1696
  s_waitcnt lgkmcnt(13)
  v_mfma_f32_32x32x16_bf16 v[148:163], a[32:35], v[92:95], v[148:163]
  ds_read_b128 v[108:111], v23 offset:24576
  ds_read_b128 v[112:115], v23 offset:28672
  buffer_load_dwordx4 v12, s[12:15], s88 offen offset:2048 lds
  ds_read_b32 v61, v36 offset:1824
  ds_read_b32 v62, v36 offset:1952
  ds_read_b32 v63, v36 offset:9504
  v_mfma_f32_32x32x16_bf16 v[164:179], a[32:35], v[96:99], v[164:179]
  ds_read_b32 v64, v36 offset:9632
  ds_read_b32 v65, v36 offset:9760
  ds_read_b32 v66, v36 offset:9888
  ds_read_b32 v67, v36 offset:10016
  ds_read_b32 v68, v36 offset:10144
  s_waitcnt lgkmcnt(13)
  v_mfma_f32_4x4x4_16b_bf16 v[196:199], v[180:181], a[36:37], v[196:199]
  v_mfma_f32_32x32x16_bf16 v[116:131], a[36:39], v[100:103], v[116:131]
  ds_read_b64_tr_b16 a[40:41], v27 offset:4096
  ds_read_b64_tr_b16 a[42:43], v27 offset:4608
  buffer_load_dwordx4 v13, s[12:15], s88 offen offset:3072 lds
  s_add_u32 m0, s23, 32768
  ds_read_b32 v69, v36 offset:10272
  ds_read_b32 v70, v36 offset:10400
  v_mfma_f32_4x4x4_16b_bf16 v[200:203], v[180:181], a[38:39], v[200:203]
  v_mfma_f32_32x32x16_bf16 v[132:147], a[36:39], v[104:107], v[132:147]
  ds_read_b128 v[84:87], v24 offset:16384
  ds_read_b128 v[88:91], v24 offset:20480
  v_lshlrev_b32 v76, 16, v72
  v_and_b32 v77, 0xffff0000, v72
  v_lshlrev_b32 v78, 16, v73
  s_waitcnt lgkmcnt(14)
  v_mfma_f32_32x32x16_bf16 v[148:163], a[36:39], v[108:111], v[148:163]
  ds_read_b128 v[92:95], v24 offset:24576
  ds_read_b128 v[96:99], v24 offset:28672
  buffer_load_dwordx4 v14, s[8:11], s96 offen offset:0 lds
  v_and_b32 v79, 0xffff0000, v73
  v_lshlrev_b32 v80, 16, v74
  v_and_b32 v81, 0xffff0000, v74
  v_mfma_f32_32x32x16_bf16 v[164:179], a[36:39], v[112:115], v[164:179]
  v_lshlrev_b32 v82, 16, v75
  v_and_b32 v83, 0xffff0000, v75
  s_waitcnt lgkmcnt(4)
  v_lshlrev_b32 v212, 16, v52
  v_lshlrev_b32 v213, 16, v53
  s_waitcnt lgkmcnt(2)
  v_mfma_f32_4x4x4_16b_bf16 v[196:199], v[180:181], a[40:41], v[196:199]
  v_mfma_f32_32x32x16_bf16 v[116:131], a[40:43], v[84:87], v[116:131]
  ds_read_b64_tr_b16 a[44:45], v27 offset:6144
  ds_read_b64_tr_b16 a[46:47], v27 offset:6656
  buffer_load_dwordx4 v15, s[8:11], s96 offen offset:1024 lds
  v_lshlrev_b32 v214, 16, v54
  v_lshlrev_b32 v215, 16, v55
  v_lshlrev_b32 v216, 16, v56
  v_mfma_f32_4x4x4_16b_bf16 v[200:203], v[180:181], a[42:43], v[200:203]
  v_mfma_f32_32x32x16_bf16 v[132:147], a[40:43], v[88:91], v[132:147]
  ds_read_b128 v[100:103], v25 offset:16384
  ds_read_b128 v[104:107], v25 offset:20480
  v_lshlrev_b32 v217, 16, v57
  v_lshlrev_b32 v218, 16, v58
  v_lshlrev_b32 v219, 16, v59
  s_waitcnt lgkmcnt(4)
  v_mfma_f32_32x32x16_bf16 v[148:163], a[40:43], v[92:95], v[148:163]
  ds_read_b128 v[108:111], v25 offset:24576
  ds_read_b128 v[112:115], v25 offset:28672
  buffer_load_dwordx4 v16, s[8:11], s96 offen offset:2048 lds
  v_lshlrev_b32 v220, 16, v60
  v_lshlrev_b32 v221, 16, v61
  v_lshlrev_b32 v222, 16, v62
  v_mfma_f32_32x32x16_bf16 v[164:179], a[40:43], v[96:99], v[164:179]
  buffer_load_dwordx4 v17, s[8:11], s96 offen offset:3072 lds
  v_mul_f32 v223, v212, v79
  v_lshlrev_b32 v225, 16, v63
  v_fmac_f32 v223, v213, v78
  v_fmac_f32 v223, v214, v77
  s_waitcnt lgkmcnt(2)
  v_mfma_f32_4x4x4_16b_bf16 v[196:199], v[180:181], a[44:45], v[196:199]
  v_mfma_f32_32x32x16_bf16 v[116:131], a[44:47], v[100:103], v[116:131]
  v_fmac_f32 v223, v215, v76
  v_mul_f32 v223, v223, v225
  v_mul_f32 v224, v213, v79
  v_lshlrev_b32 v225, 16, v64
  v_fmac_f32 v224, v214, v78
  v_fmac_f32 v224, v215, v77
  v_fmac_f32 v224, v216, v76
  v_mul_f32 v224, v224, v225
  v_cvt_pk_bf16_f32 v35, v224, v223
  v_mul_f32 v223, v214, v79
  v_lshlrev_b32 v225, 16, v65
  v_fmac_f32 v223, v215, v78
  v_fmac_f32 v223, v216, v77
  v_fmac_f32 v223, v217, v76
  v_mul_f32 v223, v223, v225
  v_mul_f32 v224, v215, v79
  v_lshlrev_b32 v225, 16, v66
  v_fmac_f32 v224, v216, v78
  v_fmac_f32 v224, v217, v77
  v_fmac_f32 v224, v218, v76
  v_mul_f32 v224, v224, v225
  v_cvt_pk_bf16_f32 v34, v224, v223
  v_mul_f32 v223, v216, v79
  v_lshlrev_b32 v225, 16, v67
  v_fmac_f32 v223, v217, v78
  v_fmac_f32 v223, v218, v77
  v_fmac_f32 v223, v219, v76
  v_mul_f32 v223, v223, v225
  v_mul_f32 v224, v217, v79
  v_lshlrev_b32 v225, 16, v68
  v_fmac_f32 v224, v218, v78
  v_fmac_f32 v224, v219, v77
  v_fmac_f32 v224, v220, v76
  v_mul_f32 v224, v224, v225
  v_cvt_pk_bf16_f32 v33, v224, v223
  v_mul_f32 v223, v218, v79
  v_lshlrev_b32 v225, 16, v69
  v_fmac_f32 v223, v219, v78
  v_fmac_f32 v223, v220, v77
  v_fmac_f32 v223, v221, v76
  v_mul_f32 v223, v223, v225
  v_mul_f32 v224, v219, v79
  v_lshlrev_b32 v225, 16, v70
  v_fmac_f32 v224, v220, v78
  v_fmac_f32 v224, v221, v77
  v_fmac_f32 v224, v222, v76
  v_mul_f32 v224, v224, v225
  v_cvt_pk_bf16_f32 v32, v224, v223
  v_and_b32 v212, 0xffff0000, v52
  v_and_b32 v213, 0xffff0000, v53
  v_and_b32 v214, 0xffff0000, v54
  v_and_b32 v215, 0xffff0000, v55
  v_and_b32 v216, 0xffff0000, v56
  v_and_b32 v217, 0xffff0000, v57
  v_and_b32 v218, 0xffff0000, v58
  v_and_b32 v219, 0xffff0000, v59
  v_and_b32 v220, 0xffff0000, v60
  v_and_b32 v221, 0xffff0000, v61
  v_and_b32 v222, 0xffff0000, v62
  v_mul_f32 v223, v212, v83
  s_waitcnt vmcnt(8) lgkmcnt(0)
  s_barrier
  ds_read_b64_tr_b16 a[48:49], v26 offset:0
  ds_read_b64_tr_b16 a[50:51], v26 offset:512
  v_and_b32 v225, 0xffff0000, v63
  v_fmac_f32 v223, v213, v82
  v_mfma_f32_4x4x4_16b_bf16 v[200:203], v[180:181], a[46:47], v[200:203]
  v_mfma_f32_32x32x16_bf16 v[132:147], a[44:47], v[104:107], v[132:147]
  ds_read_b128 v[84:87], v18 offset:16384
  ds_read_b128 v[88:91], v18 offset:20480
  s_add_u32 m0, s24, 65536
  v_fmac_f32 v223, v214, v81
  v_fmac_f32 v223, v215, v80
  v_mfma_f32_32x32x16_bf16 v[148:163], a[44:47], v[108:111], v[148:163]
  ds_read_b128 v[92:95], v18 offset:24576
  ds_read_b128 v[96:99], v18 offset:28672
  buffer_load_dwordx4 v10, s[12:15], s89 offen offset:0 lds
  v_mul_f32 v223, v223, v225
  v_mul_f32 v224, v213, v83
  v_and_b32 v225, 0xffff0000, v64
  v_mfma_f32_32x32x16_bf16 v[164:179], a[44:47], v[112:115], v[164:179]
  v_fmac_f32 v224, v214, v82
  v_fmac_f32 v224, v215, v81
  v_fmac_f32 v224, v216, v80
  v_mul_f32 v224, v224, v225
  v_cvt_pk_bf16_f32 v253, v224, v223
  s_waitcnt lgkmcnt(2)
  v_mfma_f32_4x4x4_16b_bf16 v[196:199], v[180:181], a[48:49], v[196:199]
  v_mfma_f32_32x32x16_bf16 v[116:131], a[48:51], v[84:87], v[116:131]
  ds_read_b64_tr_b16 a[52:53], v26 offset:2048
  ds_read_b64_tr_b16 a[54:55], v26 offset:2560
  buffer_load_dwordx4 v11, s[12:15], s89 offen offset:1024 lds
  v_mul_f32 v223, v214, v83
  v_and_b32 v225, 0xffff0000, v65
  v_fmac_f32 v223, v215, v82
  v_mfma_f32_4x4x4_16b_bf16 v[200:203], v[180:181], a[50:51], v[200:203]
  v_mfma_f32_32x32x16_bf16 v[132:147], a[48:51], v[88:91], v[132:147]
  ds_read_b128 v[100:103], v19 offset:16384
  ds_read_b128 v[104:107], v19 offset:20480
  v_fmac_f32 v223, v216, v81
  v_fmac_f32 v223, v217, v80
  v_mul_f32 v223, v223, v225
  s_waitcnt lgkmcnt(4)
  v_mfma_f32_32x32x16_bf16 v[148:163], a[48:51], v[92:95], v[148:163]
  ds_read_b128 v[108:111], v19 offset:24576
  ds_read_b128 v[112:115], v19 offset:28672
  buffer_load_dwordx4 v12, s[12:15], s89 offen offset:2048 lds
  v_mul_f32 v224, v215, v83
  v_and_b32 v225, 0xffff0000, v66
  v_fmac_f32 v224, v216, v82
  v_mfma_f32_32x32x16_bf16 v[164:179], a[48:51], v[96:99], v[164:179]
  v_fmac_f32 v224, v217, v81
  v_fmac_f32 v224, v218, v80
  v_mul_f32 v224, v224, v225
  v_cvt_pk_bf16_f32 v252, v224, v223
  v_mul_f32 v223, v216, v83
  s_waitcnt lgkmcnt(2)
  v_mfma_f32_4x4x4_16b_bf16 v[196:199], v[180:181], a[52:53], v[196:199]
  v_mfma_f32_32x32x16_bf16 v[116:131], a[52:55], v[100:103], v[116:131]
  ds_read_b64_tr_b16 a[56:57], v26 offset:4096
  ds_read_b64_tr_b16 a[58:59], v26 offset:4608
  buffer_load_dwordx4 v13, s[12:15], s89 offen offset:3072 lds
  s_add_u32 m0, s23, 65536
  v_and_b32 v225, 0xffff0000, v67
  v_fmac_f32 v223, v217, v82
  v_mfma_f32_4x4x4_16b_bf16 v[200:203], v[180:181], a[54:55], v[200:203]
  v_mfma_f32_32x32x16_bf16 v[132:147], a[52:55], v[104:107], v[132:147]
  ds_read_b128 v[84:87], v20 offset:16384
  ds_read_b128 v[88:91], v20 offset:20480
  v_fmac_f32 v223, v218, v81
  v_fmac_f32 v223, v219, v80
  v_mul_f32 v223, v223, v225
  s_waitcnt lgkmcnt(4)
  v_mfma_f32_32x32x16_bf16 v[148:163], a[52:55], v[108:111], v[148:163]
  ds_read_b128 v[92:95], v20 offset:24576
  ds_read_b128 v[96:99], v20 offset:28672
  buffer_load_dwordx4 v14, s[8:11], s97 offen offset:0 lds
  v_mul_f32 v224, v217, v83
  v_and_b32 v225, 0xffff0000, v68
  v_fmac_f32 v224, v218, v82
  v_mfma_f32_32x32x16_bf16 v[164:179], a[52:55], v[112:115], v[164:179]
  v_fmac_f32 v224, v219, v81
  v_fmac_f32 v224, v220, v80
  v_mul_f32 v224, v224, v225
  v_cvt_pk_bf16_f32 v251, v224, v223
  v_mul_f32 v223, v218, v83
  s_waitcnt lgkmcnt(2)
  v_mfma_f32_4x4x4_16b_bf16 v[196:199], v[180:181], a[56:57], v[196:199]
  v_mfma_f32_32x32x16_bf16 v[116:131], a[56:59], v[84:87], v[116:131]
  ds_read_b64_tr_b16 a[60:61], v26 offset:6144
  ds_read_b64_tr_b16 a[62:63], v26 offset:6656
  buffer_load_dwordx4 v15, s[8:11], s97 offen offset:1024 lds
  v_and_b32 v225, 0xffff0000, v69
  v_fmac_f32 v223, v219, v82
  v_fmac_f32 v223, v220, v81
  v_mfma_f32_4x4x4_16b_bf16 v[200:203], v[180:181], a[58:59], v[200:203]
  v_mfma_f32_32x32x16_bf16 v[132:147], a[56:59], v[88:91], v[132:147]
  ds_read_b128 v[100:103], v21 offset:16384
  ds_read_b128 v[104:107], v21 offset:20480
  v_fmac_f32 v223, v221, v80
  v_mul_f32 v223, v223, v225
  v_mul_f32 v224, v219, v83
  s_waitcnt lgkmcnt(4)
  v_mfma_f32_32x32x16_bf16 v[148:163], a[56:59], v[92:95], v[148:163]
  ds_read_b128 v[108:111], v21 offset:24576
  ds_read_b128 v[112:115], v21 offset:28672
  buffer_load_dwordx4 v16, s[8:11], s97 offen offset:2048 lds
  v_and_b32 v225, 0xffff0000, v70
  v_fmac_f32 v224, v220, v82
  v_fmac_f32 v224, v221, v81
  v_mfma_f32_32x32x16_bf16 v[164:179], a[56:59], v[96:99], v[164:179]
  buffer_load_dwordx4 v17, s[8:11], s97 offen offset:3072 lds
  v_fmac_f32 v224, v222, v80
  v_mul_f32 v224, v224, v225
  v_cvt_pk_bf16_f32 v250, v224, v223
  s_waitcnt lgkmcnt(2)
  v_mfma_f32_4x4x4_16b_bf16 v[196:199], v[180:181], a[60:61], v[196:199]
  v_mfma_f32_32x32x16_bf16 v[116:131], a[60:63], v[100:103], v[116:131]
  s_waitcnt vmcnt(8) lgkmcnt(0)
  s_barrier
  ds_read_b64_tr_b16 a[64:65], v26 offset:32768
  ds_read_b64_tr_b16 a[66:67], v26 offset:33280
  v_mfma_f32_4x4x4_16b_bf16 v[200:203], v[180:181], a[62:63], v[200:203]
  v_mfma_f32_32x32x16_bf16 v[132:147], a[60:63], v[104:107], v[132:147]
  ds_read_b128 v[84:87], v18 offset:49152
  ds_read_b128 v[88:91], v18 offset:53248
  s_add_u32 m0, s24, 0
  v_mfma_f32_32x32x16_bf16 v[148:163], a[60:63], v[108:111], v[148:163]
  ds_read_b128 v[92:95], v18 offset:57344
  ds_read_b128 v[96:99], v18 offset:61440
  buffer_load_dwordx4 v10, s[12:15], s90 offen offset:0 lds
  v_mfma_f32_32x32x16_bf16 v[164:179], a[60:63], v[112:115], v[164:179]
  s_waitcnt lgkmcnt(2)
  v_mfma_f32_4x4x4_16b_bf16 v[196:199], v[180:181], a[64:65], v[196:199]
  v_mfma_f32_32x32x16_bf16 v[116:131], a[64:67], v[84:87], v[116:131]
  ds_read_b64_tr_b16 a[68:69], v26 offset:34816
  ds_read_b64_tr_b16 a[70:71], v26 offset:35328
  buffer_load_dwordx4 v11, s[12:15], s90 offen offset:1024 lds
  v_mfma_f32_4x4x4_16b_bf16 v[200:203], v[180:181], a[66:67], v[200:203]
  v_mfma_f32_32x32x16_bf16 v[132:147], a[64:67], v[88:91], v[132:147]
  ds_read_b128 v[100:103], v19 offset:49152
  ds_read_b128 v[104:107], v19 offset:53248
  s_waitcnt lgkmcnt(4)
  v_mfma_f32_32x32x16_bf16 v[148:163], a[64:67], v[92:95], v[148:163]
  ds_read_b128 v[108:111], v19 offset:57344
  ds_read_b128 v[112:115], v19 offset:61440
  buffer_load_dwordx4 v12, s[12:15], s90 offen offset:2048 lds
  v_mfma_f32_32x32x16_bf16 v[164:179], a[64:67], v[96:99], v[164:179]
  s_waitcnt lgkmcnt(2)
  v_mfma_f32_4x4x4_16b_bf16 v[196:199], v[180:181], a[68:69], v[196:199]
  v_mfma_f32_32x32x16_bf16 v[116:131], a[68:71], v[100:103], v[116:131]
  ds_read_b64_tr_b16 a[72:73], v26 offset:36864
  ds_read_b64_tr_b16 a[74:75], v26 offset:37376
  buffer_load_dwordx4 v13, s[12:15], s90 offen offset:3072 lds
  s_add_u32 m0, s23, 0
  v_mfma_f32_4x4x4_16b_bf16 v[200:203], v[180:181], a[70:71], v[200:203]
  v_mfma_f32_32x32x16_bf16 v[132:147], a[68:71], v[104:107], v[132:147]
  ds_read_b128 v[84:87], v20 offset:49152
  ds_read_b128 v[88:91], v20 offset:53248
  s_waitcnt lgkmcnt(4)
  v_mfma_f32_32x32x16_bf16 v[148:163], a[68:71], v[108:111], v[148:163]
  ds_read_b128 v[92:95], v20 offset:57344
  ds_read_b128 v[96:99], v20 offset:61440
  buffer_load_dwordx4 v14, s[8:11], s98 offen offset:0 lds
  v_mfma_f32_32x32x16_bf16 v[164:179], a[68:71], v[112:115], v[164:179]
  s_waitcnt lgkmcnt(2)
  v_mfma_f32_4x4x4_16b_bf16 v[196:199], v[180:181], a[72:73], v[196:199]
  v_mfma_f32_32x32x16_bf16 v[116:131], a[72:75], v[84:87], v[116:131]
  ds_read_b64_tr_b16 a[76:77], v26 offset:38912
  ds_read_b64_tr_b16 a[78:79], v26 offset:39424
  buffer_load_dwordx4 v15, s[8:11], s98 offen offset:1024 lds
  v_mfma_f32_4x4x4_16b_bf16 v[200:203], v[180:181], a[74:75], v[200:203]
  v_mfma_f32_32x32x16_bf16 v[132:147], a[72:75], v[88:91], v[132:147]
  ds_read_b128 v[100:103], v21 offset:49152
  ds_read_b128 v[104:107], v21 offset:53248
  s_waitcnt lgkmcnt(4)
  v_mfma_f32_32x32x16_bf16 v[148:163], a[72:75], v[92:95], v[148:163]
  ds_read_b128 v[108:111], v21 offset:57344
  ds_read_b128 v[112:115], v21 offset:61440
  buffer_load_dwordx4 v16, s[8:11], s98 offen offset:2048 lds
  v_mfma_f32_32x32x16_bf16 v[164:179], a[72:75], v[96:99], v[164:179]
  buffer_load_dwordx4 v17, s[8:11], s98 offen offset:3072 lds
  s_waitcnt lgkmcnt(2)
  v_mfma_f32_4x4x4_16b_bf16 v[196:199], v[180:181], a[76:77], v[196:199]
  v_mfma_f32_32x32x16_bf16 v[116:131], a[76:79], v[100:103], v[116:131]
  s_waitcnt vmcnt(8) lgkmcnt(0)
  s_barrier
  ds_read_b64_tr_b16 a[80:81], v27 offset:0
  ds_read_b64_tr_b16 a[82:83], v27 offset:512
  buffer_load_dwordx4 v[52:55], v29, s[16:19], s29 offen offset:0 sc1
  buffer_load_dwordx4 v[56:59], v29, s[16:19], s29 offen offset:512 sc1
  v_mfma_f32_4x4x4_16b_bf16 v[200:203], v[180:181], a[78:79], v[200:203]
  v_mfma_f32_32x32x16_bf16 v[132:147], a[76:79], v[104:107], v[132:147]
  ds_read_b128 v[84:87], v22 offset:16384
  ds_read_b128 v[88:91], v22 offset:20480
  s_add_u32 m0, s24, 32768
  buffer_load_dwordx4 v[60:63], v29, s[16:19], s29 offen offset:1024 sc1
  buffer_load_dwordx4 v[64:67], v29, s[16:19], s29 offen offset:1536 sc1
  v_mfma_f32_32x32x16_bf16 v[148:163], a[76:79], v[108:111], v[148:163]
  ds_read_b128 v[92:95], v22 offset:24576
  ds_read_b128 v[96:99], v22 offset:28672
  buffer_load_dwordx4 v10, s[12:15], s91 offen offset:0 lds
  buffer_load_dwordx4 v[68:71], v29, s[16:19], s29 offen offset:2048 sc1
  buffer_load_dwordx4 v[72:75], v29, s[16:19], s29 offen offset:2560 sc1
  buffer_load_dwordx4 v[76:79], v29, s[16:19], s29 offen offset:3072 sc1
  v_mfma_f32_32x32x16_bf16 v[164:179], a[76:79], v[112:115], v[164:179]
  buffer_load_dwordx4 v[80:83], v29, s[16:19], s29 offen offset:3584 sc1
  s_waitcnt lgkmcnt(2)
  v_mfma_f32_4x4x4_16b_bf16 v[196:199], v[180:181], a[80:81], v[196:199]
  v_mfma_f32_32x32x16_bf16 v[116:131], a[80:83], v[84:87], v[116:131]
  ds_read_b64_tr_b16 a[84:85], v27 offset:2048
  ds_read_b64_tr_b16 a[86:87], v27 offset:2560
  buffer_load_dwordx4 v11, s[12:15], s91 offen offset:1024 lds
  v_mfma_f32_4x4x4_16b_bf16 v[200:203], v[180:181], a[82:83], v[200:203]
  v_mfma_f32_32x32x16_bf16 v[132:147], a[80:83], v[88:91], v[132:147]
  ds_read_b128 v[100:103], v23 offset:16384
  ds_read_b128 v[104:107], v23 offset:20480
  s_waitcnt lgkmcnt(4)
  v_mfma_f32_32x32x16_bf16 v[148:163], a[80:83], v[92:95], v[148:163]
  ds_read_b128 v[108:111], v23 offset:24576
  ds_read_b128 v[112:115], v23 offset:28672
  buffer_load_dwordx4 v12, s[12:15], s91 offen offset:2048 lds
  v_mfma_f32_32x32x16_bf16 v[164:179], a[80:83], v[96:99], v[164:179]
  s_waitcnt lgkmcnt(2)
  v_mfma_f32_4x4x4_16b_bf16 v[196:199], v[180:181], a[84:85], v[196:199]
  v_mfma_f32_32x32x16_bf16 v[116:131], a[84:87], v[100:103], v[116:131]
  ds_read_b64_tr_b16 a[88:89], v27 offset:4096
  ds_read_b64_tr_b16 a[90:91], v27 offset:4608
  buffer_load_dwordx4 v13, s[12:15], s91 offen offset:3072 lds
  s_add_u32 m0, s23, 32768
  v_mfma_f32_4x4x4_16b_bf16 v[200:203], v[180:181], a[86:87], v[200:203]
  v_mfma_f32_32x32x16_bf16 v[132:147], a[84:87], v[104:107], v[132:147]
  ds_read_b128 v[84:87], v24 offset:16384
  ds_read_b128 v[88:91], v24 offset:20480
  s_waitcnt lgkmcnt(4)
  v_mfma_f32_32x32x16_bf16 v[148:163], a[84:87], v[108:111], v[148:163]
  ds_read_b128 v[92:95], v24 offset:24576
  ds_read_b128 v[96:99], v24 offset:28672
  buffer_load_dwordx4 v14, s[8:11], s99 offen offset:0 lds
  v_mfma_f32_32x32x16_bf16 v[164:179], a[84:87], v[112:115], v[164:179]
  s_waitcnt lgkmcnt(2)
  v_mfma_f32_4x4x4_16b_bf16 v[196:199], v[180:181], a[88:89], v[196:199]
  v_mfma_f32_32x32x16_bf16 v[116:131], a[88:91], v[84:87], v[116:131]
  ds_read_b64_tr_b16 a[92:93], v27 offset:6144
  ds_read_b64_tr_b16 a[94:95], v27 offset:6656
  buffer_load_dwordx4 v15, s[8:11], s99 offen offset:1024 lds
  v_mfma_f32_4x4x4_16b_bf16 v[200:203], v[180:181], a[90:91], v[200:203]
  v_mfma_f32_32x32x16_bf16 v[132:147], a[88:91], v[88:91], v[132:147]
  ds_read_b128 v[100:103], v25 offset:16384
  ds_read_b128 v[104:107], v25 offset:20480
  s_waitcnt lgkmcnt(4)
  v_mfma_f32_32x32x16_bf16 v[148:163], a[88:91], v[92:95], v[148:163]
  ds_read_b128 v[108:111], v25 offset:24576
  ds_read_b128 v[112:115], v25 offset:28672
  buffer_load_dwordx4 v16, s[8:11], s99 offen offset:2048 lds
  v_mfma_f32_32x32x16_bf16 v[164:179], a[88:91], v[96:99], v[164:179]
  buffer_load_dwordx4 v17, s[8:11], s99 offen offset:3072 lds
  s_waitcnt lgkmcnt(2)
  v_mfma_f32_4x4x4_16b_bf16 v[196:199], v[180:181], a[92:93], v[196:199]
  v_mfma_f32_32x32x16_bf16 v[116:131], a[92:95], v[100:103], v[116:131]
  s_waitcnt vmcnt(16) lgkmcnt(0)
  s_barrier
  ds_read_b64_tr_b16 a[96:97], v26 offset:0
  ds_read_b64_tr_b16 a[98:99], v26 offset:512
  v_mfma_f32_4x4x4_16b_bf16 v[200:203], v[180:181], a[94:95], v[200:203]
  v_mfma_f32_32x32x16_bf16 v[132:147], a[92:95], v[104:107], v[132:147]
  ds_read_b128 v[84:87], v18 offset:16384
  ds_read_b128 v[88:91], v18 offset:20480
  s_add_u32 m0, s25, 65536
  v_mfma_f32_32x32x16_bf16 v[148:163], a[92:95], v[108:111], v[148:163]
  ds_read_b128 v[92:95], v18 offset:24576
  ds_read_b128 v[96:99], v18 offset:28672
  s_add_u32 s26, s50, 0
  buffer_load_dwordx4 v14, s[8:11], s26 offen offset:0 lds
  v_mfma_f32_32x32x16_bf16 v[164:179], a[92:95], v[112:115], v[164:179]
  s_waitcnt lgkmcnt(2)
  v_mfma_f32_4x4x4_16b_bf16 v[196:199], v[180:181], a[96:97], v[196:199]
  v_mfma_f32_32x32x16_bf16 v[116:131], a[96:99], v[84:87], v[116:131]
  ds_read_b64_tr_b16 a[100:101], v26 offset:2048
  ds_read_b64_tr_b16 a[102:103], v26 offset:2560
  buffer_load_dwordx4 v15, s[8:11], s26 offen offset:1024 lds
  v_mfma_f32_4x4x4_16b_bf16 v[200:203], v[180:181], a[98:99], v[200:203]
  v_mfma_f32_32x32x16_bf16 v[132:147], a[96:99], v[88:91], v[132:147]
  ds_read_b128 v[100:103], v19 offset:16384
  ds_read_b128 v[104:107], v19 offset:20480
  s_waitcnt lgkmcnt(4)
  v_mfma_f32_32x32x16_bf16 v[148:163], a[96:99], v[92:95], v[148:163]
  ds_read_b128 v[108:111], v19 offset:24576
  ds_read_b128 v[112:115], v19 offset:28672
  buffer_load_dwordx4 v16, s[8:11], s26 offen offset:2048 lds
  v_mfma_f32_32x32x16_bf16 v[164:179], a[96:99], v[96:99], v[164:179]
  s_waitcnt lgkmcnt(2)
  v_mfma_f32_4x4x4_16b_bf16 v[196:199], v[180:181], a[100:101], v[196:199]
  v_mfma_f32_32x32x16_bf16 v[116:131], a[100:103], v[100:103], v[116:131]
  ds_read_b64_tr_b16 a[104:105], v26 offset:4096
  ds_read_b64_tr_b16 a[106:107], v26 offset:4608
  buffer_load_dwordx4 v17, s[8:11], s26 offen offset:3072 lds
  s_add_u32 m0, s25, 69632
  v_mfma_f32_4x4x4_16b_bf16 v[200:203], v[180:181], a[102:103], v[200:203]
  v_mfma_f32_32x32x16_bf16 v[132:147], a[100:103], v[104:107], v[132:147]
  ds_read_b128 v[84:87], v20 offset:16384
  ds_read_b128 v[88:91], v20 offset:20480
  s_add_u32 s27, s51, 0
  s_waitcnt lgkmcnt(4)
  v_mfma_f32_32x32x16_bf16 v[148:163], a[100:103], v[108:111], v[148:163]
  ds_read_b128 v[92:95], v20 offset:24576
  ds_read_b128 v[96:99], v20 offset:28672
  buffer_load_dwordx4 v14, s[8:11], s27 offen offset:0 lds
  v_mfma_f32_32x32x16_bf16 v[164:179], a[100:103], v[112:115], v[164:179]
  s_waitcnt lgkmcnt(2)
  v_mfma_f32_4x4x4_16b_bf16 v[196:199], v[180:181], a[104:105], v[196:199]
  v_mfma_f32_32x32x16_bf16 v[116:131], a[104:107], v[84:87], v[116:131]
  ds_read_b64_tr_b16 a[108:109], v26 offset:6144
  ds_read_b64_tr_b16 a[110:111], v26 offset:6656
  buffer_load_dwordx4 v15, s[8:11], s27 offen offset:1024 lds
  v_mfma_f32_4x4x4_16b_bf16 v[200:203], v[180:181], a[106:107], v[200:203]
  v_mfma_f32_32x32x16_bf16 v[132:147], a[104:107], v[88:91], v[132:147]
  ds_read_b128 v[100:103], v21 offset:16384
  ds_read_b128 v[104:107], v21 offset:20480
  s_waitcnt lgkmcnt(4)
  v_mfma_f32_32x32x16_bf16 v[148:163], a[104:107], v[92:95], v[148:163]
  ds_read_b128 v[108:111], v21 offset:24576
  ds_read_b128 v[112:115], v21 offset:28672
  buffer_load_dwordx4 v16, s[8:11], s27 offen offset:2048 lds
  v_mfma_f32_32x32x16_bf16 v[164:179], a[104:107], v[96:99], v[164:179]
  buffer_load_dwordx4 v17, s[8:11], s27 offen offset:3072 lds
  s_waitcnt lgkmcnt(2)
  v_mfma_f32_4x4x4_16b_bf16 v[196:199], v[180:181], a[108:109], v[196:199]
  v_mfma_f32_32x32x16_bf16 v[116:131], a[108:111], v[100:103], v[116:131]
  s_waitcnt vmcnt(8) lgkmcnt(0)
  s_barrier
  ds_read_b64_tr_b16 a[112:113], v26 offset:32768
  ds_read_b64_tr_b16 a[114:115], v26 offset:33280
  v_mfma_f32_4x4x4_16b_bf16 v[200:203], v[180:181], a[110:111], v[200:203]
  v_mfma_f32_32x32x16_bf16 v[132:147], a[108:111], v[104:107], v[132:147]
  ds_read_b128 v[84:87], v18 offset:49152
  ds_read_b128 v[88:91], v18 offset:53248
  s_add_u32 m0, s25, 0
  v_cmp_ne_u32 vcc, s48, v55
  v_mfma_f32_32x32x16_bf16 v[148:163], a[108:111], v[108:111], v[148:163]
  ds_read_b128 v[92:95], v18 offset:57344
  ds_read_b128 v[96:99], v18 offset:61440
  s_add_u32 s26, s50, 32768
  buffer_load_dwordx4 v14, s[8:11], s26 offen offset:0 lds
  v_cmp_ne_u32 s[4:5], s48, v59
  s_or_b64 vcc, vcc, s[4:5]
  v_mfma_f32_32x32x16_bf16 v[164:179], a[108:111], v[112:115], v[164:179]
  v_cmp_ne_u32 s[4:5], s48, v63
  s_or_b64 vcc, vcc, s[4:5]
  v_cmp_ne_u32 s[4:5], s48, v67
  s_or_b64 vcc, vcc, s[4:5]
  v_cmp_ne_u32 s[4:5], s48, v71
  s_waitcnt lgkmcnt(2)
  v_mfma_f32_4x4x4_16b_bf16 v[196:199], v[180:181], a[112:113], v[196:199]
  v_mfma_f32_32x32x16_bf16 v[116:131], a[112:115], v[84:87], v[116:131]
  ds_read_b64_tr_b16 a[116:117], v26 offset:34816
  ds_read_b64_tr_b16 a[118:119], v26 offset:35328
  buffer_load_dwordx4 v15, s[8:11], s26 offen offset:1024 lds
  s_or_b64 vcc, vcc, s[4:5]
  v_cmp_ne_u32 s[4:5], s48, v75
  s_or_b64 vcc, vcc, s[4:5]
  v_mfma_f32_4x4x4_16b_bf16 v[200:203], v[180:181], a[114:115], v[200:203]
  v_mfma_f32_32x32x16_bf16 v[132:147], a[112:115], v[88:91], v[132:147]
  ds_read_b128 v[100:103], v19 offset:49152
  ds_read_b128 v[104:107], v19 offset:53248
  v_cmp_ne_u32 s[4:5], s48, v79
  s_or_b64 vcc, vcc, s[4:5]
  v_cmp_ne_u32 s[4:5], s48, v83
  s_waitcnt lgkmcnt(4)
  v_mfma_f32_32x32x16_bf16 v[148:163], a[112:115], v[92:95], v[148:163]
  ds_read_b128 v[108:111], v19 offset:57344
  ds_read_b128 v[112:115], v19 offset:61440
  buffer_load_dwordx4 v16, s[8:11], s26 offen offset:2048 lds
  s_or_b64 vcc, vcc, s[4:5]
  s_cbranch_vccnz L_slow_rec
L_ok_rec:
  v_mov_b32 v44, v52
  v_mfma_f32_32x32x16_bf16 v[164:179], a[112:115], v[96:99], v[164:179]
  v_mov_b32 v48, v56
  s_waitcnt lgkmcnt(2)
  v_mfma_f32_4x4x4_16b_bf16 v[196:199], v[180:181], a[116:117], v[196:199]
  v_mfma_f32_32x32x16_bf16 v[116:131], a[116:119], v[100:103], v[116:131]
  ds_read_b64_tr_b16 a[120:121], v26 offset:36864
  ds_read_b64_tr_b16 a[122:123], v26 offset:37376
  buffer_load_dwordx4 v17, s[8:11], s26 offen offset:3072 lds
  s_add_u32 m0, s25, 4096
  v_mfma_f32_4x4x4_16b_bf16 v[200:203], v[180:181], a[118:119], v[200:203]
  v_mfma_f32_32x32x16_bf16 v[132:147], a[116:119], v[104:107], v[132:147]
  ds_read_b128 v[84:87], v20 offset:49152
  ds_read_b128 v[88:91], v20 offset:53248
  s_add_u32 s27, s51, 32768
  s_waitcnt lgkmcnt(4)
  v_mfma_f32_32x32x16_bf16 v[148:163], a[116:119], v[108:111], v[148:163]
  ds_read_b128 v[92:95], v20 offset:57344
  ds_read_b128 v[96:99], v20 offset:61440
  buffer_load_dwordx4 v14, s[8:11], s27 offen offset:0 lds
  v_mfma_f32_32x32x16_bf16 v[164:179], a[116:119], v[112:115], v[164:179]
  s_waitcnt lgkmcnt(2)
  v_mfma_f32_4x4x4_16b_bf16 v[196:199], v[180:181], a[120:121], v[196:199]
  v_mfma_f32_32x32x16_bf16 v[116:131], a[120:123], v[84:87], v[116:131]
  ds_read_b64_tr_b16 a[124:125], v26 offset:38912
  ds_read_b64_tr_b16 a[126:127], v26 offset:39424
  buffer_load_dwordx4 v15, s[8:11], s27 offen offset:1024 lds
  v_mfma_f32_4x4x4_16b_bf16 v[200:203], v[180:181], a[122:123], v[200:203]
  v_mfma_f32_32x32x16_bf16 v[132:147], a[120:123], v[88:91], v[132:147]
  ds_read_b128 v[100:103], v21 offset:49152
  ds_read_b128 v[104:107], v21 offset:53248
  s_waitcnt lgkmcnt(4)
  v_mfma_f32_32x32x16_bf16 v[148:163], a[120:123], v[92:95], v[148:163]
  ds_read_b128 v[108:111], v21 offset:57344
  ds_read_b128 v[112:115], v21 offset:61440
  buffer_load_dwordx4 v16, s[8:11], s27 offen offset:2048 lds
  v_mfma_f32_32x32x16_bf16 v[164:179], a[120:123], v[96:99], v[164:179]
  buffer_load_dwordx4 v17, s[8:11], s27 offen offset:3072 lds
  s_lshl_b32 s6, s74, 11
  s_add_u32 m0, s6, s55
  s_waitcnt lgkmcnt(2)
  v_mfma_f32_4x4x4_16b_bf16 v[196:199], v[180:181], a[124:125], v[196:199]
  v_mfma_f32_32x32x16_bf16 v[116:131], a[124:127], v[100:103], v[116:131]
  s_waitcnt vmcnt(8) lgkmcnt(0)
  s_barrier
  ds_read_b128 v[84:87], v22 offset:0
  ds_read_b128 v[88:91], v23 offset:0
  s_add_u32 m0, m0, 32
  v_mfma_f32_4x4x4_16b_bf16 v[200:203], v[180:181], a[126:127], v[200:203]
  v_mfma_f32_32x32x16_bf16 v[132:147], a[124:127], v[104:107], v[132:147]
  ds_read_b128 v[92:95], v24 offset:0
  ds_read_b128 v[96:99], v25 offset:0
  buffer_load_dwordx4 v31, s[40:43], s6 offen offset:0 lds
  v_mfma_f32_32x32x16_bf16 v[148:163], a[124:127], v[108:111], v[148:163]
  v_add_f32 v196, v196, v200
  v_mov_b32 v197, v196
  s_nop 1
  v_permlane32_swap_b32 v196, v197
  v_add_f32 v196, v196, v197
  buffer_load_dwordx4 v31, s[40:43], s6 offen offset:1024 lds
  v_mfma_f32_32x32x16_bf16 v[164:179], a[124:127], v[112:115], v[164:179]
  v_cvt_pk_bf16_f32 v184, v196, v196
  v_and_b32 v184, 0xffff0000, v184
  v_sub_f32 v185, v196, v184
  v_cvt_pk_bf16_f32 v184, v184, v185
  v_and_b32 v40, v186, v184
  ds_read_b128 v[100:103], v22 offset:4096
  ds_read_b128 v[104:107], v23 offset:4096
  ds_read_b128 v[108:111], v24 offset:4096
  s_nop 0
  v_mfma_f32_32x32x16_bf16 v[116:131], v[40:43], v[44:47], v[116:131]
  v_mov_b32 v44, v60
  s_nop 0
  v_mfma_f32_32x32x16_bf16 v[132:147], v[40:43], v[48:51], v[132:147]
  v_mov_b32 v48, v64
  s_nop 0
  v_mfma_f32_32x32x16_bf16 v[148:163], v[40:43], v[44:47], v[148:163]
  v_mov_b32 v44, v68
  s_nop 0
  v_mfma_f32_32x32x16_bf16 v[164:179], v[40:43], v[48:51], v[164:179]
  v_mov_b32 v48, v72
  s_nop 0
  v_mfma_f32_32x32x16_bf16 v[180:195], v[40:43], v[44:47], 0
  v_mov_b32 v44, v76
  buffer_load_ushort v248, v248, s[40:43], 0 offen
  buffer_load_ushort v254, off, s[80:83], s31
  s_waitcnt lgkmcnt(3)
  v_mfma_f32_32x32x16_bf16 v[180:195], a[0:3], v[84:87], v[180:195]
  ds_read_b128 v[112:115], v25 offset:4096
  s_mov_b32 s34, 4096
  buffer_store_dwordx4 v[32:35], v37, s[16:19], 0 offen sc1
  v_mfma_f32_32x32x16_bf16 v[180:195], a[4:7], v[88:91], v[180:195]
  ds_read_b128 v[84:87], v22 offset:8192
  buffer_store_dwordx4 v[250:253], v37, s[16:19], s34 offen sc1
  v_add_u32 v2, 0x20000, v236
  v_mfma_f32_32x32x16_bf16 v[180:195], a[8:11], v[92:95], v[180:195]
  ds_read_b128 v[88:91], v23 offset:8192
  v_add_u32 v3, 0x20000, v237
  v_mul_f32 v116, v116, v54
  v_mul_f32 v117, v117, v54
  v_exp_f32 v212, v116
  v_mfma_f32_32x32x16_bf16 v[180:195], a[12:15], v[96:99], v[180:195]
  ds_read_b128 v[92:95], v24 offset:8192
  s_lshl_b32 s6, s20, 31
  s_lshl_b32 s7, s20, 30
  s_or_b32 s6, s6, s7
  v_mul_f32 v118, v118, v54
  s_waitcnt lgkmcnt(3)
  v_mfma_f32_32x32x16_bf16 v[180:195], a[16:19], v[100:103], v[180:195]
  ds_read_b128 v[96:99], v25 offset:8192
  s_and_b32 s6, s6, 0x80000000
  v_or_b32 v9, s6, v8
  v_exp_f32 v213, v117
  v_mul_f32 v119, v119, v54
  v_mfma_f32_32x32x16_bf16 v[180:195], a[20:23], v[104:107], v[180:195]
  ds_read_b128 v[100:103], v22 offset:12288
  s_add_u32 m0, s25, 32768
  v_mul_f32 v120, v116, v120
  v_exp_f32 v214, v118
  v_mul_f32 v124, v124, v54
  v_mfma_f32_32x32x16_bf16 v[180:195], a[24:27], v[108:111], v[180:195]
  ds_read_b128 v[104:107], v23 offset:12288
  s_add_u32 s26, s50, 65536
  buffer_load_dwordx4 v14, s[8:11], s26 offen offset:0 lds
  v_mul_f32 v121, v117, v121
  v_exp_f32 v215, v119
  v_mfma_f32_32x32x16_bf16 v[180:195], a[28:31], v[112:115], v[180:195]
  ds_read_b128 v[108:111], v24 offset:12288
  v_mul_f32 v125, v125, v54
  v_fma_f32 v212, v212, v53, v53
  v_mul_f32 v122, v118, v122
  s_waitcnt lgkmcnt(3)
  v_mfma_f32_32x32x16_bf16 v[180:195], a[32:35], v[84:87], v[180:195]
  ds_read_b128 v[112:115], v25 offset:12288
  buffer_load_dwordx4 v15, s[8:11], s26 offen offset:1024 lds
  v_exp_f32 v216, v124
  v_mul_f32 v126, v126, v54
  v_fma_f32 v213, v213, v53, v53
  v_mfma_f32_32x32x16_bf16 v[180:195], a[36:39], v[88:91], v[180:195]
  ds_read_b128 v[84:87], v22 offset:16384
  v_mul_f32 v123, v119, v123
  v_exp_f32 v217, v125
  v_mul_f32 v127, v127, v54
  v_mfma_f32_32x32x16_bf16 v[180:195], a[40:43], v[92:95], v[180:195]
  ds_read_b128 v[88:91], v23 offset:16384
  buffer_load_dwordx4 v16, s[8:11], s26 offen offset:2048 lds
  v_rcp_f32 v212, v212
  v_fma_f32 v214, v214, v53, v53
  v_mul_f32 v128, v124, v128
  v_mfma_f32_32x32x16_bf16 v[180:195], a[44:47], v[96:99], v[180:195]
  ds_read_b128 v[92:95], v24 offset:16384
  v_exp_f32 v218, v126
  v_rcp_f32 v213, v213
  s_waitcnt lgkmcnt(3)
  v_mfma_f32_32x32x16_bf16 v[180:195], a[48:51], v[100:103], v[180:195]
  ds_read_b128 v[96:99], v25 offset:16384
  buffer_load_dwordx4 v17, s[8:11], s26 offen offset:3072 lds
  s_add_u32 m0, s25, 36864
  v_fma_f32 v215, v215, v53, v53
  v_mul_f32 v129, v125, v129
  v_mfma_f32_32x32x16_bf16 v[180:195], a[52:55], v[104:107], v[180:195]
  ds_read_b128 v[100:103], v22 offset:20480
  s_add_u32 s27, s51, 65536
  v_exp_f32 v219, v127
  v_mul_f32 v120, v120, v212
  v_mfma_f32_32x32x16_bf16 v[180:195], a[56:59], v[108:111], v[180:195]
  ds_read_b128 v[104:107], v23 offset:20480
  buffer_load_dwordx4 v14, s[8:11], s27 offen offset:0 lds
  v_rcp_f32 v214, v214
  v_fma_f32 v216, v216, v53, v53
  v_mul_f32 v130, v126, v130
  v_mfma_f32_32x32x16_bf16 v[180:195], a[60:63], v[112:115], v[180:195]
  ds_read_b128 v[108:111], v24 offset:20480
  v_mul_f32 v121, v121, v213
  v_rcp_f32 v215, v215
  v_cvt_pk_bf16_f32 v220, v120, v121
  s_waitcnt lgkmcnt(3)
  v_mfma_f32_32x32x16_bf16 v[180:195], a[64:67], v[84:87], v[180:195]
  ds_read_b128 v[112:115], v25 offset:20480
  buffer_load_dwordx4 v15, s[8:11], s27 offen offset:1024 lds
  v_fma_f32 v217, v217, v53, v53
  v_mul_f32 v131, v127, v131
  v_mul_f32 v122, v122, v214
  v_mfma_f32_32x32x16_bf16 v[180:195], a[68:71], v[88:91], v[180:195]
  ds_read_b128 v[84:87], v22 offset:24576
  v_rcp_f32 v216, v216
  v_fma_f32 v218, v218, v53, v53
  v_mul_f32 v123, v123, v215
  v_mfma_f32_32x32x16_bf16 v[180:195], a[72:75], v[92:95], v[180:195]
  ds_read_b128 v[88:91], v23 offset:24576
  buffer_load_dwordx4 v16, s[8:11], s27 offen offset:2048 lds
  v_rcp_f32 v217, v217
  v_cvt_pk_bf16_f32 v221, v122, v123
  v_fma_f32 v219, v219, v53, v53
  v_mfma_f32_32x32x16_bf16 v[180:195], a[76:79], v[96:99], v[180:195]
  ds_read_b128 v[92:95], v24 offset:24576
  buffer_load_dwordx4 v17, s[8:11], s27 offen offset:3072 lds
  v_mul_f32 v128, v128, v216
  v_rcp_f32 v218, v218
  s_waitcnt lgkmcnt(3)
  v_mfma_f32_32x32x16_bf16 v[180:195], a[80:83], v[100:103], v[180:195]
  ds_read_b128 v[96:99], v25 offset:24576
  v_mul_f32 v129, v129, v217
  v_rcp_f32 v219, v219
  v_cvt_pk_bf16_f32 v222, v128, v129
  v_mul_f32 v130, v130, v218
  v_mfma_f32_32x32x16_bf16 v[180:195], a[84:87], v[104:107], v[180:195]
  ds_read_b128 v[100:103], v22 offset:28672
  s_add_u32 m0, s77, 141312
  v_mul_f32 v131, v131, v219
  v_cvt_pk_bf16_f32 v223, v130, v131
  s_add_u32 s35, s28, 0
  buffer_store_dwordx4 v[220:223], v31, s[16:19], s35 offen sc1
  v_mfma_f32_32x32x16_bf16 v[180:195], a[88:91], v[108:111], v[180:195]
  ds_read_b128 v[104:107], v23 offset:28672
  buffer_load_dwordx4 v228, s[36:39], s60 offen offset:0 lds
  v_mul_f32 v132, v132, v58
  v_mul_f32 v133, v133, v58
  v_exp_f32 v212, v132
  v_mfma_f32_32x32x16_bf16 v[180:195], a[92:95], v[112:115], v[180:195]
  ds_read_b128 v[108:111], v24 offset:28672
  v_mul_f32 v134, v134, v58
  v_exp_f32 v213, v133
  v_mul_f32 v135, v135, v58
  s_waitcnt lgkmcnt(3)
  v_mfma_f32_32x32x16_bf16 v[180:195], a[96:99], v[84:87], v[180:195]
  ds_read_b128 v[112:115], v25 offset:28672
  buffer_load_dwordx4 v229, s[36:39], s60 offen offset:1024 lds
  v_mul_f32 v136, v132, v136
  v_exp_f32 v214, v134
  v_mul_f32 v140, v140, v58
  v_mfma_f32_32x32x16_bf16 v[180:195], a[100:103], v[88:91], v[180:195]
  s_waitcnt vmcnt(17) lgkmcnt(0)
  s_barrier
  ds_read_b128 v[84:87], v18 offset:0
  v_mul_f32 v137, v133, v137
  v_exp_f32 v215, v135
  v_mfma_f32_32x32x16_bf16 v[180:195], a[104:107], v[92:95], v[180:195]
  ds_read_b128 v[88:91], v19 offset:0
  buffer_load_dwordx4 v230, s[36:39], s60 offen offset:2048 lds
  v_mul_f32 v141, v141, v58
  v_fma_f32 v212, v212, v57, v57
  v_mul_f32 v138, v134, v138
  v_mfma_f32_32x32x16_bf16 v[180:195], a[108:111], v[96:99], v[180:195]
  ds_read_b128 v[92:95], v20 offset:0
  v_exp_f32 v216, v140
  v_mul_f32 v142, v142, v58
  v_fma_f32 v213, v213, v57, v57
  v_mfma_f32_32x32x16_bf16 v[180:195], a[112:115], v[100:103], v[180:195]
  ds_read_b128 v[96:99], v21 offset:0
  buffer_load_dwordx4 v231, s[36:39], s60 offen offset:3072 lds
  s_add_u32 m0, s25, 65536
  v_mul_f32 v139, v135, v139
  v_exp_f32 v217, v141
  v_mfma_f32_32x32x16_bf16 v[180:195], a[116:119], v[104:107], v[180:195]
  ds_read_b128 v[100:103], v18 offset:4096
  s_add_u32 s26, s50, 98304
  v_mul_f32 v143, v143, v58
  v_rcp_f32 v212, v212
  v_fma_f32 v214, v214, v57, v57
  v_mfma_f32_32x32x16_bf16 v[180:195], a[120:123], v[108:111], v[180:195]
  ds_read_b128 v[104:107], v19 offset:4096
  buffer_load_dwordx4 v14, s[8:11], s26 offen offset:0 lds
  v_mul_f32 v144, v140, v144
  v_exp_f32 v218, v142
  v_mfma_f32_32x32x16_bf16 v[180:195], a[124:127], v[112:115], v[180:195]
  ds_read_b128 v[108:111], v20 offset:4096
  v_rcp_f32 v213, v213
  v_fma_f32 v215, v215, v57, v57
  v_mul_f32 v145, v141, v145
  v_mfma_f32_32x32x16_bf16 v[196:211], v[40:43], v[48:51], 0
  v_mov_b32 v48, v80
  buffer_load_dwordx4 v15, s[8:11], s26 offen offset:1024 lds
  v_exp_f32 v219, v143
  v_mul_f32 v136, v136, v212
  s_waitcnt lgkmcnt(3)
  v_mfma_f32_32x32x16_bf16 v[196:211], a[0:3], v[84:87], v[196:211]
  ds_read_b128 v[112:115], v21 offset:4096
  v_rcp_f32 v214, v214
  v_fma_f32 v216, v216, v57, v57
  v_mul_f32 v146, v142, v146
  v_mul_f32 v137, v137, v213
  v_mfma_f32_32x32x16_bf16 v[196:211], a[4:7], v[88:91], v[196:211]
  ds_read_b128 v[84:87], v18 offset:8192
  buffer_load_dwordx4 v16, s[8:11], s26 offen offset:2048 lds
  v_rcp_f32 v215, v215
  v_cvt_pk_bf16_f32 v224, v136, v137
  v_fma_f32 v217, v217, v57, v57
  v_mfma_f32_32x32x16_bf16 v[196:211], a[8:11], v[92:95], v[196:211]
  ds_read_b128 v[88:91], v19 offset:8192
  v_mul_f32 v147, v143, v147
  v_mul_f32 v138, v138, v214
  v_rcp_f32 v216, v216
  v_fma_f32 v218, v218, v57, v57
  v_mfma_f32_32x32x16_bf16 v[196:211], a[12:15], v[96:99], v[196:211]
  ds_read_b128 v[92:95], v20 offset:8192
  buffer_load_dwordx4 v17, s[8:11], s26 offen offset:3072 lds
  s_waitcnt vmcnt(17)
  v_mul_f32 v139, v139, v215
  s_waitcnt lgkmcnt(3)
  v_mfma_f32_32x32x16_bf16 v[196:211], a[16:19], v[100:103], v[196:211]
  ds_read_b128 v[96:99], v21 offset:8192
  buffer_store_dwordx2 v[6:7], v8, s[16:19], s30 offen sc1
  s_add_u32 m0, s25, 69632
  v_rcp_f32 v217, v217
  v_cvt_pk_bf16_f32 v225, v138, v139
  v_mfma_f32_32x32x16_bf16 v[196:211], a[20:23], v[104:107], v[196:211]
  ds_read_b128 v[100:103], v18 offset:12288
  s_add_u32 s27, s51, 98304
  buffer_load_dwordx4 v14, s[8:11], s27 offen offset:0 lds
  v_fma_f32 v219, v219, v57, v57
  v_mul_f32 v144, v144, v216
  v_mfma_f32_32x32x16_bf16 v[196:211], a[24:27], v[108:111], v[196:211]
  ds_read_b128 v[104:107], v19 offset:12288
  v_rcp_f32 v218, v218
  v_mul_f32 v145, v145, v217
  v_rcp_f32 v219, v219
  v_mfma_f32_32x32x16_bf16 v[196:211], a[28:31], v[112:115], v[196:211]
  ds_read_b128 v[108:111], v20 offset:12288
  buffer_load_dwordx4 v15, s[8:11], s27 offen offset:1024 lds
  v_cvt_pk_bf16_f32 v226, v144, v145
  v_mul_f32 v146, v146, v218
  v_mul_f32 v147, v147, v219
  s_waitcnt lgkmcnt(3)
  v_mfma_f32_32x32x16_bf16 v[196:211], a[32:35], v[84:87], v[196:211]
  ds_read_b128 v[112:115], v21 offset:12288
  buffer_load_dwordx4 v16, s[8:11], s27 offen offset:2048 lds
  v_cvt_pk_bf16_f32 v227, v146, v147
  s_add_u32 s35, s28, 114688
  buffer_store_dwordx4 v[224:227], v31, s[16:19], s35 offen sc1
  v_mul_f32 v148, v148, v62
  v_mfma_f32_32x32x16_bf16 v[196:211], a[36:39], v[88:91], v[196:211]
  ds_read_b128 v[84:87], v18 offset:16384
  buffer_load_dwordx4 v17, s[8:11], s27 offen offset:3072 lds
  v_mul_f32 v149, v149, v62
  v_exp_f32 v212, v148
  v_mul_f32 v150, v150, v62
  v_mfma_f32_32x32x16_bf16 v[196:211], a[40:43], v[92:95], v[196:211]
  ds_read_b128 v[88:91], v19 offset:16384
  v_exp_f32 v213, v149
  v_mul_f32 v151, v151, v62
  v_mul_f32 v152, v148, v152
  v_mfma_f32_32x32x16_bf16 v[196:211], a[44:47], v[96:99], v[196:211]
  ds_read_b128 v[92:95], v20 offset:16384
  v_exp_f32 v214, v150
  v_mul_f32 v156, v156, v62
  v_mul_f32 v153, v149, v153
  s_waitcnt lgkmcnt(3)
  v_mfma_f32_32x32x16_bf16 v[196:211], a[48:51], v[100:103], v[196:211]
  ds_read_b128 v[96:99], v21 offset:16384
  s_add_u32 m0, s77, 124416
  v_exp_f32 v215, v151
  v_mul_f32 v157, v157, v62
  v_fma_f32 v212, v212, v61, v61
  v_mfma_f32_32x32x16_bf16 v[196:211], a[52:55], v[104:107], v[196:211]
  ds_read_b128 v[100:103], v18 offset:20480
  buffer_load_dwordx4 v228, s[36:39], s65 offen offset:0 lds
  v_mul_f32 v154, v150, v154
  v_exp_f32 v216, v156
  v_mul_f32 v158, v158, v62
  v_mfma_f32_32x32x16_bf16 v[196:211], a[56:59], v[108:111], v[196:211]
  ds_read_b128 v[104:107], v19 offset:20480
  v_fma_f32 v213, v213, v61, v61
  v_mul_f32 v155, v151, v155
  v_exp_f32 v217, v157
  v_mul_f32 v159, v159, v62
  v_mfma_f32_32x32x16_bf16 v[196:211], a[60:63], v[112:115], v[196:211]
  ds_read_b128 v[108:111], v20 offset:20480
  buffer_load_dwordx4 v229, s[36:39], s65 offen offset:1024 lds
  v_rcp_f32 v212, v212
  v_fma_f32 v214, v214, v61, v61
  s_waitcnt lgkmcnt(3)
  v_mfma_f32_32x32x16_bf16 v[196:211], a[64:67], v[84:87], v[196:211]
  ds_read_b128 v[112:115], v21 offset:20480
  v_mul_f32 v160, v156, v160
  v_exp_f32 v218, v158
  v_rcp_f32 v213, v213
  v_mfma_f32_32x32x16_bf16 v[196:211], a[68:71], v[88:91], v[196:211]
  ds_read_b128 v[84:87], v18 offset:24576
  buffer_load_dwordx4 v230, s[36:39], s65 offen offset:2048 lds
  v_fma_f32 v215, v215, v61, v61
  v_mul_f32 v161, v157, v161
  v_exp_f32 v219, v159
  v_mfma_f32_32x32x16_bf16 v[196:211], a[72:75], v[92:95], v[196:211]
  ds_read_b128 v[88:91], v19 offset:24576
  v_mul_f32 v152, v152, v212
  v_rcp_f32 v214, v214
  v_fma_f32 v216, v216, v61, v61
  v_mul_f32 v162, v158, v162
  v_mfma_f32_32x32x16_bf16 v[196:211], a[76:79], v[96:99], v[196:211]
  ds_read_b128 v[92:95], v20 offset:24576
  buffer_load_dwordx4 v231, s[36:39], s65 offen offset:3072 lds
  v_mul_f32 v153, v153, v213
  v_rcp_f32 v215, v215
  s_waitcnt lgkmcnt(3)
  v_mfma_f32_32x32x16_bf16 v[196:211], a[80:83], v[100:103], v[196:211]
  ds_read_b128 v[96:99], v21 offset:24576
  v_cvt_pk_bf16_f32 v220, v152, v153
  v_fma_f32 v217, v217, v61, v61
  v_mul_f32 v163, v159, v163
  v_mul_f32 v154, v154, v214
  v_mfma_f32_32x32x16_bf16 v[196:211], a[84:87], v[104:107], v[196:211]
  ds_read_b128 v[100:103], v18 offset:28672
  v_rcp_f32 v216, v216
  v_fma_f32 v218, v218, v61, v61
  v_mul_f32 v155, v155, v215
  v_mfma_f32_32x32x16_bf16 v[196:211], a[88:91], v[108:111], v[196:211]
  ds_read_b128 v[104:107], v19 offset:28672
  v_rcp_f32 v217, v217
  v_cvt_pk_bf16_f32 v221, v154, v155
  v_fma_f32 v219, v219, v61, v61
  v_mul_f32 v160, v160, v216
  v_mfma_f32_32x32x16_bf16 v[196:211], a[92:95], v[112:115], v[196:211]
  ds_read_b128 v[108:111], v20 offset:28672
  v_rcp_f32 v218, v218
  v_mul_f32 v161, v161, v217
  s_waitcnt lgkmcnt(3)
  v_mfma_f32_32x32x16_bf16 v[196:211], a[96:99], v[84:87], v[196:211]
  ds_read_b128 v[112:115], v21 offset:28672
  v_rcp_f32 v219, v219
  v_cvt_pk_bf16_f32 v222, v160, v161
  v_mul_f32 v162, v162, v218
  v_mul_f32 v163, v163, v219
  v_mfma_f32_32x32x16_bf16 v[196:211], a[100:103], v[88:91], v[196:211]
  s_waitcnt vmcnt(19) lgkmcnt(0)
  s_barrier
  ds_read_b128 v[84:87], v18 offset:32768
  v_cvt_pk_bf16_f32 v223, v162, v163
  s_add_u32 s35, s28, 229376
  buffer_store_dwordx4 v[220:223], v31, s[16:19], s35 offen sc1
  v_mfma_f32_32x32x16_bf16 v[196:211], a[104:107], v[92:95], v[196:211]
  ds_read_b128 v[88:91], v19 offset:32768
  s_add_u32 m0, s77, 0
  v_mul_f32 v164, v164, v66
  v_mul_f32 v165, v165, v66
  v_exp_f32 v212, v164
  v_mfma_f32_32x32x16_bf16 v[196:211], a[108:111], v[96:99], v[196:211]
  ds_read_b128 v[92:95], v20 offset:32768
  buffer_load_dwordx4 v228, s[36:39], s61 offen offset:0 lds
  v_mul_f32 v166, v166, v66
  v_exp_f32 v213, v165
  v_mfma_f32_32x32x16_bf16 v[196:211], a[112:115], v[100:103], v[196:211]
  ds_read_b128 v[96:99], v21 offset:32768
  s_lshl_b32 s5, s74, 11
  s_add_u32 s5, s5, s55
  v_mul_f32 v167, v167, v66
  v_mul_f32 v168, v164, v168
  v_mfma_f32_32x32x16_bf16 v[196:211], a[116:119], v[104:107], v[196:211]
  ds_read_b128 v[100:103], v18 offset:36864
  buffer_load_dwordx4 v229, s[36:39], s61 offen offset:1024 lds
  v_add_u32 v39, s5, v31
  v_exp_f32 v214, v166
  v_mul_f32 v172, v172, v66
  v_mfma_f32_32x32x16_bf16 v[196:211], a[120:123], v[108:111], v[196:211]
  ds_read_b128 v[104:107], v19 offset:36864
  ds_write_b16 v249, v248
  ds_read_b128 v[10:13], v39 offset:32
  v_mul_f32 v169, v165, v169
  v_exp_f32 v215, v167
  v_mfma_f32_32x32x16_bf16 v[196:211], a[124:127], v[112:115], v[196:211]
  ds_read_b128 v[108:111], v20 offset:36864
  buffer_load_dwordx4 v230, s[36:39], s61 offen offset:2048 lds
  ds_read_b32 v26, v39 offset:48
  v_mul_f32 v173, v173, v66
  v_fma_f32 v212, v212, v65, v65
  v_mfma_f32_32x32x16_bf16 v[116:131], v[40:43], v[44:47], 0
  v_mul_f32 v170, v166, v170
  v_exp_f32 v216, v172
  v_mul_f32 v174, v174, v66
  v_fma_f32 v213, v213, v65, v65
  s_waitcnt lgkmcnt(6)
  v_mfma_f32_32x32x16_bf16 v[116:131], a[0:3], v[84:87], v[116:131]
  ds_read_b128 v[112:115], v21 offset:36864
  buffer_load_dwordx4 v231, s[36:39], s61 offen offset:3072 lds
  s_add_u32 m0, s77, 16384
  v_mul_f32 v171, v167, v171
  v_exp_f32 v217, v173
  v_mfma_f32_32x32x16_bf16 v[116:131], a[4:7], v[88:91], v[116:131]
  ds_read_b128 v[84:87], v18 offset:40960
  v_mul_f32 v175, v175, v66
  v_rcp_f32 v212, v212
  v_fma_f32 v214, v214, v65, v65
  v_mul_f32 v176, v172, v176
  v_mfma_f32_32x32x16_bf16 v[116:131], a[8:11], v[92:95], v[116:131]
  ds_read_b128 v[88:91], v19 offset:40960
  buffer_load_dwordx4 v228, s[36:39], s62 offen offset:0 lds
  v_exp_f32 v218, v174
  v_rcp_f32 v213, v213
  v_mfma_f32_32x32x16_bf16 v[116:131], a[12:15], v[96:99], v[116:131]
  ds_read_b128 v[92:95], v20 offset:40960
  v_fma_f32 v215, v215, v65, v65
  v_mul_f32 v177, v173, v177
  v_exp_f32 v219, v175
  s_waitcnt lgkmcnt(3)
  v_mfma_f32_32x32x16_bf16 v[116:131], a[16:19], v[100:103], v[116:131]
  ds_read_b128 v[96:99], v21 offset:40960
  buffer_load_dwordx4 v229, s[36:39], s62 offen offset:1024 lds
  v_mul_f32 v168, v168, v212
  v_rcp_f32 v214, v214
  v_mfma_f32_32x32x16_bf16 v[116:131], a[20:23], v[104:107], v[116:131]
  ds_read_b128 v[100:103], v18 offset:45056
  v_alignbit_b32 v32, v11, v10, 16
  v_alignbit_b32 v33, v12, v11, 16
  v_fma_f32 v216, v216, v65, v65
  v_mul_f32 v178, v174, v178
  v_mul_f32 v169, v169, v213
  v_mfma_f32_32x32x16_bf16 v[116:131], a[24:27], v[108:111], v[116:131]
  ds_read_b128 v[104:107], v19 offset:45056
  buffer_load_dwordx4 v230, s[36:39], s62 offen offset:2048 lds
  v_alignbit_b32 v34, v13, v12, 16
  v_rcp_f32 v215, v215
  v_cvt_pk_bf16_f32 v224, v168, v169
  v_mfma_f32_32x32x16_bf16 v[116:131], a[28:31], v[112:115], v[116:131]
  ds_read_b128 v[108:111], v20 offset:45056
  buffer_load_dwordx4 v231, s[36:39], s62 offen offset:3072 lds
  v_alignbit_b32 v35, v26, v13, 16
  v_fma_f32 v217, v217, v65, v65
  v_mul_f32 v179, v175, v179
  s_waitcnt lgkmcnt(3)
  v_mfma_f32_32x32x16_bf16 v[116:131], a[32:35], v[84:87], v[116:131]
  ds_read_b128 v[112:115], v21 offset:45056
  v_mul_f32 v170, v170, v214
  v_rcp_f32 v216, v216
  v_fma_f32 v218, v218, v65, v65
  v_mul_f32 v171, v171, v215
  v_mfma_f32_32x32x16_bf16 v[116:131], a[36:39], v[88:91], v[116:131]
  ds_read_b128 v[84:87], v18 offset:49152
  ds_write_b128 v39, v[32:35] offset:4192
  v_rcp_f32 v217, v217
  v_mfma_f32_32x32x16_bf16 v[116:131], a[40:43], v[92:95], v[116:131]
  ds_read_b128 v[88:91], v19 offset:49152
  v_cvt_pk_bf16_f32 v225, v170, v171
  v_fma_f32 v219, v219, v65, v65
  v_mul_f32 v176, v176, v216
  v_rcp_f32 v218, v218
  v_mfma_f32_32x32x16_bf16 v[116:131], a[44:47], v[96:99], v[116:131]
  ds_read_b128 v[92:95], v20 offset:49152
  v_mul_f32 v177, v177, v217
  v_rcp_f32 v219, v219
  v_cvt_pk_bf16_f32 v226, v176, v177
  s_waitcnt lgkmcnt(4)
  v_mfma_f32_32x32x16_bf16 v[116:131], a[48:51], v[100:103], v[116:131]
  ds_read_b128 v[96:99], v21 offset:49152
  ds_read_b128 v[10:13], v39 offset:1056
  ds_read_b32 v26, v39 offset:1072
  v_mul_f32 v178, v178, v218
  v_mul_f32 v179, v179, v219
  v_cvt_pk_bf16_f32 v227, v178, v179
  v_mfma_f32_32x32x16_bf16 v[116:131], a[52:55], v[104:107], v[116:131]
  ds_read_b128 v[100:103], v18 offset:53248
  s_waitcnt vmcnt(23)
  ds_read_b64_tr_b16 a[128:129], v2 offset:10240
  s_add_u32 s35, s28, 344064
  buffer_store_dwordx4 v[224:227], v31, s[16:19], s35 offen sc1
  v_mul_f32 v180, v180, v70
  v_mfma_f32_32x32x16_bf16 v[116:131], a[56:59], v[108:111], v[116:131]
  ds_read_b128 v[104:107], v19 offset:53248
  ds_read_b64_tr_b16 a[130:131], v2 offset:10752
  ds_read_b64_tr_b16 a[132:133], v3 offset:10240
  v_mul_f32 v181, v181, v70
  v_exp_f32 v212, v180
  v_mfma_f32_32x32x16_bf16 v[116:131], a[60:63], v[112:115], v[116:131]
  ds_read_b128 v[108:111], v20 offset:53248
  ds_read_b64_tr_b16 a[134:135], v3 offset:10752
  ds_read_b64_tr_b16 a[136:137], v2 offset:12288
  v_mul_f32 v182, v182, v70
  s_waitcnt lgkmcnt(10)
  v_mfma_f32_32x32x16_bf16 v[116:131], a[64:67], v[84:87], v[116:131]
  ds_read_b128 v[112:115], v21 offset:53248
  ds_read_b64_tr_b16 a[138:139], v2 offset:12800
  ds_read_b64_tr_b16 a[140:141], v3 offset:12288
  v_exp_f32 v213, v181
  v_mul_f32 v183, v183, v70
  v_mfma_f32_32x32x16_bf16 v[116:131], a[68:71], v[88:91], v[116:131]
  ds_read_b128 v[84:87], v18 offset:57344
  ds_read_b64_tr_b16 a[142:143], v3 offset:12800
  v_mul_f32 v184, v180, v184
  v_exp_f32 v214, v182
  v_mul_f32 v188, v188, v70
  v_mfma_f32_32x32x16_bf16 v[116:131], a[72:75], v[92:95], v[116:131]
  ds_read_b128 v[88:91], v19 offset:57344
  s_waitcnt lgkmcnt(14)
  v_alignbit_b32 v32, v11, v10, 16
  v_mul_f32 v185, v181, v185
  v_exp_f32 v215, v183
  v_mfma_f32_32x32x16_bf16 v[116:131], a[76:79], v[96:99], v[116:131]
  ds_read_b128 v[92:95], v20 offset:57344
  v_alignbit_b32 v33, v12, v11, 16
  v_alignbit_b32 v34, v13, v12, 16
  v_mul_f32 v189, v189, v70
  v_fma_f32 v212, v212, v69, v69
  s_waitcnt lgkmcnt(6)
  v_mfma_f32_32x32x16_bf16 v[116:131], a[80:83], v[100:103], v[116:131]
  ds_read_b128 v[96:99], v21 offset:57344
  v_alignbit_b32 v35, v26, v13, 16
  v_mul_f32 v186, v182, v186
  v_exp_f32 v216, v188
  v_mul_f32 v190, v190, v70
  v_mfma_f32_32x32x16_bf16 v[116:131], a[84:87], v[104:107], v[116:131]
  ds_read_b128 v[100:103], v18 offset:61440
  v_fma_f32 v213, v213, v69, v69
  v_mul_f32 v187, v183, v187
  v_exp_f32 v217, v189
  v_mul_f32 v191, v191, v70
  v_mfma_f32_32x32x16_bf16 v[116:131], a[88:91], v[108:111], v[116:131]
  ds_read_b128 v[104:107], v19 offset:61440
  s_waitcnt lgkmcnt(5)
  s_add_u32 m0, s77, 141312
  v_rcp_f32 v212, v212
  v_fma_f32 v214, v214, v69, v69
  v_mfma_f32_32x32x16_bf16 v[116:131], a[92:95], v[112:115], v[116:131]
  ds_read_b128 v[108:111], v20 offset:61440
  buffer_load_dwordx4 v228, s[36:39], s67 offen offset:0 lds
  v_mul_f32 v192, v188, v192
  v_exp_f32 v218, v190
  s_waitcnt lgkmcnt(3)
  v_mfma_f32_32x32x16_bf16 v[116:131], a[96:99], v[84:87], v[116:131]
  ds_read_b128 v[112:115], v21 offset:61440
  ds_write_b128 v39, v[32:35] offset:5216
  v_rcp_f32 v213, v213
  v_mfma_f32_32x32x16_bf16 v[116:131], a[100:103], v[88:91], v[116:131]
  s_waitcnt vmcnt(15) lgkmcnt(0)
  s_barrier
  ds_read_b128 v[84:87], v22 offset:0
  buffer_load_dwordx4 v229, s[36:39], s67 offen offset:1024 lds
  v_fma_f32 v215, v215, v69, v69
  v_mul_f32 v193, v189, v193
  v_mfma_f32_32x32x16_bf16 v[116:131], a[104:107], v[92:95], v[116:131]
  ds_read_b128 v[88:91], v23 offset:0
  v_exp_f32 v219, v191
  v_mul_f32 v184, v184, v212
  v_rcp_f32 v214, v214
  v_mfma_f32_32x32x16_bf16 v[116:131], a[108:111], v[96:99], v[116:131]
  ds_read_b128 v[92:95], v24 offset:0
  buffer_load_dwordx4 v230, s[36:39], s67 offen offset:2048 lds
  v_fma_f32 v216, v216, v69, v69
  v_mul_f32 v194, v190, v194
  v_mul_f32 v185, v185, v213
  v_mfma_f32_32x32x16_bf16 v[116:131], a[112:115], v[100:103], v[116:131]
  ds_read_b128 v[96:99], v25 offset:0
  buffer_load_dwordx4 v231, s[36:39], s67 offen offset:3072 lds
  buffer_load_dwordx2 v[250:251], v247, s[16:19], 0 offen sc1
  v_rcp_f32 v215, v215
  v_cvt_pk_bf16_f32 v220, v184, v185
  v_mfma_f32_32x32x16_bf16 v[116:131], a[116:119], v[104:107], v[116:131]
  ds_read_b128 v[100:103], v22 offset:4096
  s_add_u32 m0, s77, 32768
  v_fma_f32 v217, v217, v69, v69
  v_mul_f32 v195, v191, v195
  v_mul_f32 v186, v186, v214
  v_mfma_f32_32x32x16_bf16 v[116:131], a[120:123], v[108:111], v[116:131]
  ds_read_b128 v[104:107], v23 offset:4096
  buffer_load_dwordx4 v228, s[36:39], s63 offen offset:0 lds
  v_rcp_f32 v216, v216
  v_fma_f32 v218, v218, v69, v69
  v_mul_f32 v187, v187, v215
  v_mfma_f32_32x32x16_bf16 v[116:131], a[124:127], v[112:115], v[116:131]
  ds_read_b128 v[108:111], v24 offset:4096
  v_rcp_f32 v217, v217
  v_cvt_pk_bf16_f32 v221, v186, v187
  v_fma_f32 v219, v219, v69, v69
  v_mfma_f32_32x32x16_bf16 v[132:147], v[40:43], v[48:51], 0
  buffer_load_dwordx4 v229, s[36:39], s63 offen offset:1024 lds
  v_mul_f32 v192, v192, v216
  v_rcp_f32 v218, v218
  v_mul_f32 v193, v193, v217
  s_waitcnt lgkmcnt(3)
  v_mfma_f32_32x32x16_bf16 v[132:147], a[0:3], v[84:87], v[132:147]
  ds_read_b128 v[112:115], v25 offset:4096
  v_rcp_f32 v219, v219
  v_cvt_pk_bf16_f32 v222, v192, v193
  v_mul_f32 v194, v194, v218
  v_mul_f32 v195, v195, v219
  v_mfma_f32_32x32x16_bf16 v[132:147], a[4:7], v[88:91], v[132:147]
  ds_read_b128 v[84:87], v22 offset:8192
  buffer_load_dwordx4 v230, s[36:39], s63 offen offset:2048 lds
  v_cvt_pk_bf16_f32 v223, v194, v195
  s_add_u32 s35, s28, 458752
  buffer_store_dwordx4 v[220:223], v31, s[16:19], s35 offen sc1
  v_mul_f32 v196, v196, v74
  v_mfma_f32_32x32x16_bf16 v[132:147], a[8:11], v[92:95], v[132:147]
  ds_read_b128 v[88:91], v23 offset:8192
  v_mul_f32 v197, v197, v74
  v_exp_f32 v212, v196
  v_mul_f32 v198, v198, v74
  v_mfma_f32_32x32x16_bf16 v[132:147], a[12:15], v[96:99], v[132:147]
  ds_read_b128 v[92:95], v24 offset:8192
  buffer_load_dwordx4 v231, s[36:39], s63 offen offset:3072 lds
  s_add_u32 m0, s77, 49152
  v_exp_f32 v213, v197
  s_waitcnt lgkmcnt(3)
  v_mfma_f32_32x32x16_bf16 v[132:147], a[16:19], v[100:103], v[132:147]
  ds_read_b128 v[96:99], v25 offset:8192
  v_mul_f32 v199, v199, v74
  v_mul_f32 v200, v196, v200
  v_exp_f32 v214, v198
  v_mul_f32 v204, v204, v74
  v_mfma_f32_32x32x16_bf16 v[132:147], a[20:23], v[104:107], v[132:147]
  ds_read_b128 v[100:103], v22 offset:12288
  buffer_load_dwordx4 v228, s[36:39], s64 offen offset:0 lds
  v_mul_f32 v201, v197, v201
  v_exp_f32 v215, v199
  v_mul_f32 v205, v205, v74
  v_mfma_f32_32x32x16_bf16 v[132:147], a[24:27], v[108:111], v[132:147]
  ds_read_b128 v[104:107], v23 offset:12288
  v_fma_f32 v212, v212, v73, v73
  v_mul_f32 v202, v198, v202
  v_exp_f32 v216, v204
  v_mul_f32 v206, v206, v74
  v_mfma_f32_32x32x16_bf16 v[132:147], a[28:31], v[112:115], v[132:147]
  ds_read_b128 v[108:111], v24 offset:12288
  buffer_load_dwordx4 v229, s[36:39], s64 offen offset:1024 lds
  v_fma_f32 v213, v213, v73, v73
  v_mul_f32 v203, v199, v203
  s_waitcnt lgkmcnt(3)
  v_mfma_f32_32x32x16_bf16 v[132:147], a[32:35], v[84:87], v[132:147]
  ds_read_b128 v[112:115], v25 offset:12288
  buffer_load_dwordx4 v230, s[36:39], s64 offen offset:2048 lds
  v_exp_f32 v217, v205
  v_mul_f32 v207, v207, v74
  v_mfma_f32_32x32x16_bf16 v[132:147], a[36:39], v[88:91], v[132:147]
  ds_read_b128 v[84:87], v22 offset:16384
  buffer_load_dwordx4 v231, s[36:39], s64 offen offset:3072 lds
  s_waitcnt vmcnt(9)
  v_rcp_f32 v212, v212
  v_fma_f32 v214, v214, v73, v73
  v_mfma_f32_32x32x16_bf16 v[132:147], a[40:43], v[92:95], v[132:147]
  ds_read_b128 v[88:91], v23 offset:16384
  v_cmp_ne_u64 vcc, s[48:49], v[250:251]
  s_cbranch_vccnz L_slow_kv
L_ok_kv:
  v_mul_f32 v208, v204, v208
  v_exp_f32 v218, v206
  v_mfma_f32_32x32x16_bf16 v[132:147], a[44:47], v[96:99], v[132:147]
  ds_read_b128 v[92:95], v24 offset:16384
  s_lshl_b32 s7, s20, 10
  s_add_u32 m0, s7, 106624
  v_rcp_f32 v213, v213
  s_waitcnt lgkmcnt(3)
  v_mfma_f32_32x32x16_bf16 v[132:147], a[48:51], v[100:103], v[132:147]
  ds_read_b128 v[96:99], v25 offset:16384
  buffer_load_dwordx4 v31, s[16:19], s56 offen offset:0 sc1 lds
  s_add_u32 s56, s56, 4096
  v_fma_f32 v215, v215, v73, v73
  v_mul_f32 v209, v205, v209
  v_mfma_f32_32x32x16_bf16 v[132:147], a[52:55], v[104:107], v[132:147]
  ds_read_b128 v[100:103], v22 offset:20480
  s_add_u32 m0, s7, 119552
  v_exp_f32 v219, v207
  v_mul_f32 v200, v200, v212
  v_mfma_f32_32x32x16_bf16 v[132:147], a[56:59], v[108:111], v[132:147]
  ds_read_b128 v[104:107], v23 offset:20480
  buffer_load_dwordx4 v31, s[16:19], s56 offen offset:0 sc1 lds
  v_rcp_f32 v214, v214
  v_fma_f32 v216, v216, v73, v73
  v_mul_f32 v210, v206, v210
  v_mfma_f32_32x32x16_bf16 v[132:147], a[60:63], v[112:115], v[132:147]
  ds_read_b128 v[108:111], v24 offset:20480
  s_barrier
  buffer_store_dwordx2 v[6:7], v9, s[16:19], s58 offen sc1
  s_add_u32 s58, s58, 131072
  s_waitcnt lgkmcnt(3)
  v_mfma_f32_32x32x16_bf16 v[132:147], a[64:67], v[84:87], v[132:147]
  ds_read_b128 v[112:115], v25 offset:20480
  v_mul_f32 v201, v201, v213
  v_rcp_f32 v215, v215
  v_cvt_pk_bf16_f32 v224, v200, v201
  v_fma_f32 v217, v217, v73, v73
  v_mfma_f32_32x32x16_bf16 v[132:147], a[68:71], v[88:91], v[132:147]
  ds_read_b128 v[84:87], v22 offset:24576
  v_mul_f32 v211, v207, v211
  v_mul_f32 v202, v202, v214
  v_rcp_f32 v216, v216
  v_fma_f32 v218, v218, v73, v73
  v_mfma_f32_32x32x16_bf16 v[132:147], a[72:75], v[92:95], v[132:147]
  ds_read_b128 v[88:91], v23 offset:24576
  v_mul_f32 v203, v203, v215
  v_rcp_f32 v217, v217
  v_cvt_pk_bf16_f32 v225, v202, v203
  v_fma_f32 v219, v219, v73, v73
  v_mfma_f32_32x32x16_bf16 v[132:147], a[76:79], v[96:99], v[132:147]
  ds_read_b128 v[92:95], v24 offset:24576
  v_mul_f32 v208, v208, v216
  v_rcp_f32 v218, v218
  v_mul_f32 v209, v209, v217
  s_waitcnt lgkmcnt(3)
  v_mfma_f32_32x32x16_bf16 v[132:147], a[80:83], v[100:103], v[132:147]
  ds_read_b128 v[96:99], v25 offset:24576
  v_rcp_f32 v219, v219
  v_cvt_pk_bf16_f32 v226, v208, v209
  v_mul_f32 v210, v210, v218
  v_mul_f32 v211, v211, v219
  v_mfma_f32_32x32x16_bf16 v[132:147], a[84:87], v[104:107], v[132:147]
  ds_read_b128 v[100:103], v22 offset:28672
  v_cvt_pk_bf16_f32 v227, v210, v211
  s_add_u32 s35, s28, 573440
  buffer_store_dwordx4 v[224:227], v31, s[16:19], s35 offen sc1
  v_mul_f32 v116, v116, v78
  v_mul_f32 v117, v117, v78
  v_mfma_f32_32x32x16_bf16 v[132:147], a[88:91], v[108:111], v[132:147]
  ds_read_b128 v[104:107], v23 offset:28672
  v_exp_f32 v212, v116
  v_mul_f32 v118, v118, v78
  v_exp_f32 v213, v117
  v_mfma_f32_32x32x16_bf16 v[132:147], a[92:95], v[112:115], v[132:147]
  ds_read_b128 v[108:111], v24 offset:28672
  v_mul_f32 v119, v119, v78
  v_mul_f32 v120, v116, v120
  v_exp_f32 v214, v118
  s_waitcnt lgkmcnt(3)
  v_mfma_f32_32x32x16_bf16 v[132:147], a[96:99], v[84:87], v[132:147]
  ds_read_b128 v[112:115], v25 offset:28672
  v_mul_f32 v124, v124, v78
  v_mul_f32 v121, v117, v121
  v_exp_f32 v215, v119
  v_mul_f32 v125, v125, v78
  v_mfma_f32_32x32x16_bf16 v[132:147], a[100:103], v[88:91], v[132:147]
  v_fma_f32 v212, v212, v77, v77
  v_mul_f32 v122, v118, v122
  v_exp_f32 v216, v124
  v_mul_f32 v126, v126, v78
  v_fma_f32 v213, v213, v77, v77
  v_mfma_f32_32x32x16_bf16 v[132:147], a[104:107], v[92:95], v[132:147]
  v_mul_f32 v123, v119, v123
  v_exp_f32 v217, v125
  v_mul_f32 v127, v127, v78
  v_rcp_f32 v212, v212
  v_mfma_f32_32x32x16_bf16 v[132:147], a[108:111], v[96:99], v[132:147]
  s_waitcnt lgkmcnt(0)
  s_barrier
  s_add_u32 m0, s77, 81920
  v_fma_f32 v214, v214, v77, v77
  v_mul_f32 v128, v124, v128
  v_mfma_f32_32x32x16_bf16 v[132:147], a[112:115], v[100:103], v[132:147]
  buffer_load_dwordx4 v228, s[36:39], s66 offen offset:0 lds
  v_exp_f32 v218, v126
  v_rcp_f32 v213, v213
  v_fma_f32 v215, v215, v77, v77
  v_mfma_f32_32x32x16_bf16 v[132:147], a[116:119], v[104:107], v[132:147]
  v_mul_f32 v129, v125, v129
  v_exp_f32 v219, v127
  v_mul_f32 v120, v120, v212
  v_rcp_f32 v214, v214
  v_mfma_f32_32x32x16_bf16 v[132:147], a[120:123], v[108:111], v[132:147]
  buffer_load_dwordx4 v229, s[36:39], s66 offen offset:1024 lds
  v_fma_f32 v216, v216, v77, v77
  v_mul_f32 v130, v126, v130
  v_mul_f32 v121, v121, v213
  v_rcp_f32 v215, v215
  v_mfma_f32_32x32x16_bf16 v[132:147], a[124:127], v[112:115], v[132:147]
  v_cvt_pk_bf16_f32 v220, v120, v121
  v_fma_f32 v217, v217, v77, v77
  v_mul_f32 v131, v127, v131
  v_mul_f32 v122, v122, v214
  v_rcp_f32 v216, v216
  v_fma_f32 v218, v218, v77, v77
  v_mul_f32 v123, v123, v215
  v_rcp_f32 v217, v217
  v_cvt_pk_bf16_f32 v221, v122, v123
  v_fma_f32 v219, v219, v77, v77
  v_mul_f32 v128, v128, v216
  v_rcp_f32 v218, v218
  v_mul_f32 v129, v129, v217
  v_rcp_f32 v219, v219
  v_cvt_pk_bf16_f32 v222, v128, v129
  v_mul_f32 v130, v130, v218
  v_mul_f32 v131, v131, v219
  v_cvt_pk_bf16_f32 v223, v130, v131
  s_add_u32 s35, s28, 688128
  buffer_store_dwordx4 v[220:223], v31, s[16:19], s35 offen sc1
  v_add_u32 v10, 1024, v240
  v_add_u32 v11, 2048, v240
  v_add_u32 v12, 3072, v240
  s_waitcnt vmcnt(5) lgkmcnt(0)
  s_barrier
  ds_read2_b32 v[148:149], v240 offset0:0 offset1:1
  ds_read2_b32 v[150:151], v240 offset0:2 offset1:3
  ds_read_b128 v[180:183], v241 offset:3584
  ds_read2_b32 v[152:153], v240 offset0:128 offset1:129
  ds_read2_b32 v[154:155], v240 offset0:130 offset1:131
  ds_read_b128 v[184:187], v241 offset:3072
  ds_read2_b32 v[156:157], v10 offset0:0 offset1:1
  ds_read2_b32 v[158:159], v10 offset0:2 offset1:3
  ds_read_b128 v[188:191], v241 offset:2560
  ds_read2_b32 v[160:161], v10 offset0:128 offset1:129
  ds_read2_b32 v[162:163], v10 offset0:130 offset1:131
  ds_read_b128 v[192:195], v241 offset:2048
  ds_read2_b32 v[164:165], v11 offset0:0 offset1:1
  ds_read2_b32 v[166:167], v11 offset0:2 offset1:3
  ds_read_b128 v[196:199], v241 offset:1536
  ds_read2_b32 v[168:169], v11 offset0:128 offset1:129
  ds_read2_b32 v[170:171], v11 offset0:130 offset1:131
  ds_read_b128 v[200:203], v241 offset:1024
  ds_read2_b32 v[172:173], v12 offset0:0 offset1:1
  ds_read2_b32 v[174:175], v12 offset0:2 offset1:3
  ds_read_b128 v[204:207], v241 offset:512
  ds_read2_b32 v[176:177], v12 offset0:128 offset1:129
  ds_read2_b32 v[178:179], v12 offset0:130 offset1:131
  ds_read_b128 v[208:211], v241 offset:0
  s_mov_b32 s84, 0
  s_mov_b32 s85, 4096
  s_mov_b32 s86, 8192
  s_mov_b32 s87, 12288
  s_mov_b32 s88, 16384
  s_mov_b32 s89, 20480
  s_mov_b32 s90, 24576
  buffer_load_dwordx4 v230, s[36:39], s66 offen offset:2048 lds
  v_mul_f32 v132, v132, v82
  v_mul_f32 v133, v133, v82
  v_exp_f32 v212, v132
  v_mul_f32 v134, v134, v82
  v_exp_f32 v213, v133
  v_mul_f32 v135, v135, v82
  v_mul_f32 v136, v132, v136
  buffer_load_dwordx4 v231, s[36:39], s66 offen offset:3072 lds
  v_exp_f32 v214, v134
  v_mul_f32 v140, v140, v82
  v_mul_f32 v137, v133, v137
  v_exp_f32 v215, v135
  v_mul_f32 v141, v141, v82
  v_fma_f32 v212, v212, v81, v81
  v_mul_f32 v138, v134, v138
  s_add_u32 m0, s77, 65536
  v_exp_f32 v216, v140
  v_mul_f32 v142, v142, v82
  v_fma_f32 v213, v213, v81, v81
  v_mul_f32 v139, v135, v139
  v_exp_f32 v217, v141
  v_mul_f32 v143, v143, v82
  v_rcp_f32 v212, v212
  buffer_load_dwordx4 v228, s[36:39], s72 offen offset:0 lds
  v_fma_f32 v214, v214, v81, v81
  v_mul_f32 v144, v140, v144
  v_exp_f32 v218, v142
  v_rcp_f32 v213, v213
  v_fma_f32 v215, v215, v81, v81
  v_mul_f32 v145, v141, v145
  v_exp_f32 v219, v143
  buffer_load_dwordx4 v229, s[36:39], s72 offen offset:1024 lds
  v_mul_f32 v136, v136, v212
  v_rcp_f32 v214, v214
  v_fma_f32 v216, v216, v81, v81
  v_mul_f32 v146, v142, v146
  v_mul_f32 v137, v137, v213
  v_rcp_f32 v215, v215
  v_cvt_pk_bf16_f32 v224, v136, v137
  buffer_load_dwordx4 v230, s[36:39], s72 offen offset:2048 lds
  v_fma_f32 v217, v217, v81, v81
  v_mul_f32 v147, v143, v147
  v_mul_f32 v138, v138, v214
  v_rcp_f32 v216, v216
  v_fma_f32 v218, v218, v81, v81
  v_mul_f32 v139, v139, v215
  v_rcp_f32 v217, v217
  buffer_load_dwordx4 v231, s[36:39], s72 offen offset:3072 lds
  v_cvt_pk_bf16_f32 v225, v138, v139
  v_fma_f32 v219, v219, v81, v81
  v_mul_f32 v144, v144, v216
  v_rcp_f32 v218, v218
  v_mul_f32 v145, v145, v217
  v_rcp_f32 v219, v219
  v_cvt_pk_bf16_f32 v226, v144, v145
  v_mul_f32 v146, v146, v218
  v_mul_f32 v147, v147, v219
  v_cvt_pk_bf16_f32 v227, v146, v147
  s_add_u32 s35, s28, 802816
  buffer_store_dwordx4 v[224:227], v31, s[16:19], s35 offen sc1
L_phase2:
  v_add_u32 v216, 0x10000, v236
  v_add_u32 v220, 0x20000, v236
  v_add_u32 v217, 0x10000, v237
  v_add_u32 v221, 0x20000, v237
  s_waitcnt lgkmcnt(15)
  v_mfma_f32_16x16x32_bf16 v[116:119], v[148:151], v[180:183], 0
  ds_read_b64_tr_b16 a[144:145], v236 offset:0
  ds_read_b64_tr_b16 a[146:147], v236 offset:512
  v_mfma_f32_16x16x32_bf16 v[120:123], v[148:151], v[184:187], 0
  ds_read_b64_tr_b16 a[148:149], v237 offset:0
  ds_read_b64_tr_b16 a[150:151], v237 offset:512
  v_mfma_f32_16x16x32_bf16 v[120:123], v[152:155], v[180:183], v[120:123]
  ds_read2_b32 v[52:53], v240 offset0:16 offset1:17
  ds_read_b64_tr_b16 a[152:153], v236 offset:2048
  v_mfma_f32_16x16x32_bf16 v[124:127], v[152:155], v[184:187], 0
  ds_read_b64_tr_b16 a[154:155], v236 offset:2560
  ds_read_b64_tr_b16 a[156:157], v237 offset:2048
  v_mfma_f32_16x16x32_bf16 v[124:127], v[148:151], v[188:191], v[124:127]
  ds_read2_b32 v[54:55], v240 offset0:18 offset1:19
  ds_read_b64_tr_b16 a[158:159], v237 offset:2560
  v_mfma_f32_16x16x32_bf16 v[124:127], v[156:159], v[180:183], v[124:127]
  ds_read_b128 v[84:87], v241 offset:3648
  ds_read_b64_tr_b16 a[160:161], v236 offset:16384
  v_mfma_f32_16x16x32_bf16 v[128:131], v[152:155], v[188:191], 0
  ds_read2_b32 v[56:57], v240 offset0:144 offset1:145
  v_lshrrev_b32 v24, 4, v1
  v_mfma_f32_16x16x32_bf16 v[128:131], v[156:159], v[184:187], v[128:131]
  v_and_b32 v25, 15, v1
  s_waitcnt lgkmcnt(3)
  s_add_u32 m0, s77, 0
  v_mfma_f32_16x16x32_bf16 v[132:135], v[156:159], v[188:191], 0
  ds_read2_b32 v[58:59], v240 offset0:146 offset1:147
  v_lshl_add_u32 v24, v24, 3, v25
  v_mfma_f32_16x16x32_bf16 v[128:131], v[148:151], v[192:195], v[128:131]
  ds_read_b128 v[88:91], v241 offset:3136
  ds_read_b64_tr_b16 a[162:163], v236 offset:16896
  v_mfma_f32_16x16x32_bf16 v[128:131], v[160:163], v[180:183], v[128:131]
  ds_read2_b32 v[60:61], v10 offset0:16 offset1:17
  v_sub_u32 v24, 15, v24
  v_mfma_f32_16x16x32_bf16 v[132:135], v[152:155], v[192:195], v[132:135]
  v_lshlrev_b32 v25, 4, v24
  buffer_load_dwordx4 v228, s[36:39], s68 offen offset:0 lds
  v_mfma_f32_16x16x32_bf16 v[132:135], v[160:163], v[184:187], v[132:135]
  ds_read2_b32 v[62:63], v10 offset0:18 offset1:19
  v_and_b32 v25, 16, v25
  v_mfma_f32_16x16x32_bf16 v[136:139], v[156:159], v[192:195], 0
  ds_read_b128 v[92:95], v241 offset:2624
  ds_read_b64_tr_b16 a[164:165], v237 offset:16384
  v_mfma_f32_16x16x32_bf16 v[136:139], v[160:163], v[188:191], v[136:139]
  ds_read2_b32 v[64:65], v10 offset0:144 offset1:145
  s_sub_u32 s3, s74, 1
  v_mfma_f32_16x16x32_bf16 v[140:143], v[160:163], v[192:195], 0
  v_lshlrev_b32 v25, v25, v254
  buffer_load_dwordx4 v229, s[36:39], s68 offen offset:1024 lds
  v_mfma_f32_16x16x32_bf16 v[132:135], v[148:151], v[196:199], v[132:135]
  ds_read2_b32 v[66:67], v10 offset0:146 offset1:147
  v_and_b32 v25, s3, v25
  v_mfma_f32_16x16x32_bf16 v[132:135], v[164:167], v[180:183], v[132:135]
  ds_read_b128 v[96:99], v241 offset:2112
  ds_read_b64_tr_b16 a[166:167], v237 offset:16896
  v_mfma_f32_16x16x32_bf16 v[136:139], v[152:155], v[196:199], v[136:139]
  ds_read2_b32 v[68:69], v11 offset0:16 offset1:17
  v_lshrrev_b32 v24, 1, v24
  v_mfma_f32_16x16x32_bf16 v[136:139], v[164:167], v[184:187], v[136:139]
  v_cmp_eq_u32 s[4:5], 0, v24
  buffer_load_dwordx4 v230, s[36:39], s68 offen offset:2048 lds
  v_mfma_f32_16x16x32_bf16 v[140:143], v[156:159], v[196:199], v[140:143]
  ds_read2_b32 v[70:71], v11 offset0:18 offset1:19
  v_cmp_eq_u32 s[6:7], 1, v24
  v_mfma_f32_16x16x32_bf16 v[140:143], v[164:167], v[188:191], v[140:143]
  ds_read_b128 v[100:103], v241 offset:1600
  ds_read_b64_tr_b16 a[168:169], v236 offset:18432
  v_mfma_f32_16x16x32_bf16 v[144:147], v[160:163], v[196:199], 0
  ds_read2_b32 v[72:73], v11 offset0:144 offset1:145
  v_cmp_eq_u32 s[34:35], 2, v24
  v_mfma_f32_16x16x32_bf16 v[144:147], v[164:167], v[192:195], v[144:147]
  v_cmp_eq_u32 vcc, 3, v24
  buffer_load_dwordx4 v231, s[36:39], s68 offen offset:3072 lds
  buffer_load_dwordx2 v[250:251], v246, s[16:19], 0 offen sc1
  v_mfma_f32_16x16x32_bf16 v[136:139], v[148:151], v[200:203], v[136:139]
  ds_read2_b32 v[74:75], v11 offset0:146 offset1:147
  v_cndmask_b32 v40, 0, v25, s[4:5]
  v_mfma_f32_16x16x32_bf16 v[136:139], v[168:171], v[180:183], v[136:139]
  ds_read_b128 v[104:107], v241 offset:1088
  ds_read_b64_tr_b16 a[170:171], v236 offset:18944
  v_mfma_f32_16x16x32_bf16 v[140:143], v[152:155], v[200:203], v[140:143]
  ds_read2_b32 v[76:77], v12 offset0:16 offset1:17
  v_cndmask_b32 v41, 0, v25, s[6:7]
  v_mfma_f32_16x16x32_bf16 v[140:143], v[168:171], v[184:187], v[140:143]
  v_cndmask_b32 v42, 0, v25, s[34:35]
  ds_read_b64_tr_b16 a[172:173], v237 offset:18432
  v_mfma_f32_16x16x32_bf16 v[144:147], v[156:159], v[200:203], v[144:147]
  ds_read2_b32 v[78:79], v12 offset0:18 offset1:19
  v_cndmask_b32 v43, 0, v25, vcc
  v_mfma_f32_16x16x32_bf16 v[144:147], v[168:171], v[188:191], v[144:147]
  ds_read_b128 v[108:111], v241 offset:576
  ds_read_b64_tr_b16 a[174:175], v237 offset:18944
  v_mfma_f32_16x16x32_bf16 v[140:143], v[148:151], v[204:207], v[140:143]
  ds_read2_b32 v[80:81], v12 offset0:144 offset1:145
  ds_read_b64_tr_b16 a[176:177], v236 offset:32768
  v_mfma_f32_16x16x32_bf16 v[140:143], v[172:175], v[180:183], v[140:143]
  s_waitcnt lgkmcnt(2)
  s_add_u32 m0, s77, 16384
  v_mfma_f32_16x16x32_bf16 v[144:147], v[152:155], v[204:207], v[144:147]
  ds_read2_b32 v[82:83], v12 offset0:146 offset1:147
  ds_read_b64_tr_b16 a[178:179], v236 offset:33280
  v_mfma_f32_16x16x32_bf16 v[144:147], v[172:175], v[184:187], v[144:147]
  ds_read_b128 v[112:115], v241 offset:64
  ds_read_b64_tr_b16 a[180:181], v237 offset:32768
  v_mfma_f32_16x16x32_bf16 v[144:147], v[148:151], v[208:211], v[144:147]
  ds_read_b64_tr_b16 a[182:183], v237 offset:33280
  ds_read_b64_tr_b16 a[184:185], v236 offset:34816
  v_mfma_f32_16x16x32_bf16 v[144:147], v[176:179], v[180:183], v[144:147]
  buffer_load_dwordx4 v228, s[36:39], s69 offen offset:0 lds
  ds_read_b64_tr_b16 a[186:187], v236 offset:35328
  v_mfma_f32_16x16x32_bf16 v[116:119], v[40:43], v[180:183], v[116:119]
  v_mfma_f32_16x16x32_bf16 v[120:123], v[40:43], v[184:187], v[120:123]
  buffer_load_dwordx4 v229, s[36:39], s69 offen offset:1024 lds
  v_mfma_f32_16x16x32_bf16 v[124:127], v[40:43], v[188:191], v[124:127]
  v_mfma_f32_16x16x32_bf16 v[128:131], v[40:43], v[192:195], v[128:131]
  v_mfma_f32_16x16x32_bf16 v[132:135], v[40:43], v[196:199], v[132:135]
  v_mfma_f32_16x16x32_bf16 v[136:139], v[40:43], v[200:203], v[136:139]
  buffer_load_dwordx4 v230, s[36:39], s69 offen offset:2048 lds
  v_mfma_f32_16x16x32_bf16 v[140:143], v[40:43], v[204:207], v[140:143]
  v_mfma_f32_16x16x32_bf16 v[144:147], v[40:43], v[208:211], v[144:147]
  s_mov_b32 s26, 131072
  buffer_load_dwordx4 v[44:47], v244, s[8:11], 0 offen
  buffer_load_dwordx4 v[48:51], v244, s[8:11], s26 offen
  buffer_load_dwordx4 v[40:43], v245, s[16:19], 0 offen offset:0 sc1
  buffer_load_dwordx4 v[224:227], v245, s[16:19], 0 offen offset:2048 sc1
  v_mfma_f32_16x16x32_bf16 v[116:119], v[52:55], v[84:87], v[116:119]
  ds_read_b64_tr_b16 a[188:189], v237 offset:34816
  ds_read_b64_tr_b16 a[190:191], v237 offset:35328
  v_mfma_f32_16x16x32_bf16 v[120:123], v[52:55], v[88:91], v[120:123]
  ds_read_b64_tr_b16 a[192:193], v236 offset:49152
  ds_read_b64_tr_b16 a[194:195], v236 offset:49664
  v_mfma_f32_16x16x32_bf16 v[120:123], v[56:59], v[84:87], v[120:123]
  ds_read2_b32 v[148:149], v240 offset0:32 offset1:33
  ds_read_b64_tr_b16 a[196:197], v237 offset:49152
  v_mfma_f32_16x16x32_bf16 v[124:127], v[56:59], v[88:91], v[124:127]
  buffer_load_dwordx4 v231, s[36:39], s69 offen offset:3072 lds
  ds_read_b64_tr_b16 a[198:199], v237 offset:49664
  v_mfma_f32_16x16x32_bf16 v[124:127], v[52:55], v[92:95], v[124:127]
  ds_read2_b32 v[150:151], v240 offset0:34 offset1:35
  ds_read_b64_tr_b16 a[200:201], v236 offset:51200
  v_mfma_f32_16x16x32_bf16 v[124:127], v[60:63], v[84:87], v[124:127]
  ds_read_b128 v[180:183], v241 offset:3712
  ds_read_b64_tr_b16 a[202:203], v236 offset:51712
  v_mfma_f32_16x16x32_bf16 v[128:131], v[56:59], v[92:95], v[128:131]
  ds_read2_b32 v[152:153], v240 offset0:160 offset1:161
  ds_read_b64_tr_b16 a[204:205], v237 offset:51200
  v_mfma_f32_16x16x32_bf16 v[128:131], v[60:63], v[88:91], v[128:131]
  s_waitcnt lgkmcnt(11)
  s_add_u32 m0, s77, 32768
  v_mfma_f32_16x16x32_bf16 v[132:135], v[60:63], v[92:95], v[132:135]
  ds_read2_b32 v[154:155], v240 offset0:162 offset1:163
  ds_read_b64_tr_b16 a[206:207], v237 offset:51712
  v_mfma_f32_16x16x32_bf16 v[128:131], v[52:55], v[96:99], v[128:131]
  ds_read_b128 v[184:187], v241 offset:3200
  ds_read_b64_tr_b16 a[208:209], v216 offset:58880
  v_mfma_f32_16x16x32_bf16 v[128:131], v[64:67], v[84:87], v[128:131]
  ds_read2_b32 v[156:157], v10 offset0:32 offset1:33
  ds_read_b64_tr_b16 a[210:211], v216 offset:59392
  v_mfma_f32_16x16x32_bf16 v[132:135], v[56:59], v[96:99], v[132:135]
  buffer_load_dwordx4 v228, s[36:39], s70 offen offset:0 lds
  ds_read_b64_tr_b16 a[212:213], v217 offset:58880
  v_mfma_f32_16x16x32_bf16 v[132:135], v[64:67], v[88:91], v[132:135]
  ds_read2_b32 v[158:159], v10 offset0:34 offset1:35
  ds_read_b64_tr_b16 a[214:215], v217 offset:59392
  v_mfma_f32_16x16x32_bf16 v[136:139], v[60:63], v[96:99], v[136:139]
  ds_read_b128 v[188:191], v241 offset:2688
  ds_read_b64_tr_b16 a[216:217], v216 offset:60928
  v_mfma_f32_16x16x32_bf16 v[136:139], v[64:67], v[92:95], v[136:139]
  ds_read2_b32 v[160:161], v10 offset0:160 offset1:161
  ds_read_b64_tr_b16 a[218:219], v216 offset:61440
  v_mfma_f32_16x16x32_bf16 v[140:143], v[64:67], v[96:99], v[140:143]
  buffer_load_dwordx4 v229, s[36:39], s70 offen offset:1024 lds
  ds_read_b64_tr_b16 a[220:221], v217 offset:60928
  v_mfma_f32_16x16x32_bf16 v[132:135], v[52:55], v[100:103], v[132:135]
  ds_read2_b32 v[162:163], v10 offset0:162 offset1:163
  ds_read_b64_tr_b16 a[222:223], v217 offset:61440
  v_mfma_f32_16x16x32_bf16 v[132:135], v[68:71], v[84:87], v[132:135]
  ds_read_b128 v[192:195], v241 offset:2176
  v_mfma_f32_16x16x32_bf16 v[136:139], v[56:59], v[100:103], v[136:139]
  ds_read2_b32 v[164:165], v11 offset0:32 offset1:33
  v_mfma_f32_16x16x32_bf16 v[136:139], v[68:71], v[88:91], v[136:139]
  buffer_load_dwordx4 v230, s[36:39], s70 offen offset:2048 lds
  v_mfma_f32_16x16x32_bf16 v[140:143], v[60:63], v[100:103], v[140:143]
  ds_read2_b32 v[166:167], v11 offset0:34 offset1:35
  v_mfma_f32_16x16x32_bf16 v[140:143], v[68:71], v[92:95], v[140:143]
  ds_read_b128 v[196:199], v241 offset:1664
  v_mfma_f32_16x16x32_bf16 v[144:147], v[64:67], v[100:103], v[144:147]
  ds_read2_b32 v[168:169], v11 offset0:160 offset1:161
  v_mfma_f32_16x16x32_bf16 v[144:147], v[68:71], v[96:99], v[144:147]
  buffer_load_dwordx4 v231, s[36:39], s70 offen offset:3072 lds
  s_waitcnt vmcnt(17)
  s_barrier
  buffer_store_dwordx2 v[6:7], v9, s[16:19], s58 offen sc1
  v_mfma_f32_16x16x32_bf16 v[136:139], v[52:55], v[104:107], v[136:139]
  ds_read2_b32 v[170:171], v11 offset0:162 offset1:163
  v_mfma_f32_16x16x32_bf16 v[136:139], v[72:75], v[84:87], v[136:139]
  ds_read_b128 v[200:203], v241 offset:1152
  s_waitcnt vmcnt(13)
  v_cmp_ne_u64 vcc, s[48:49], v[250:251]
  s_cbranch_vccnz L_slow_hA
L_ok_hA:
  v_mfma_f32_16x16x32_bf16 v[140:143], v[56:59], v[104:107], v[140:143]
  ds_read2_b32 v[172:173], v12 offset0:32 offset1:33
  v_mfma_f32_16x16x32_bf16 v[140:143], v[72:75], v[88:91], v[140:143]
  s_waitcnt lgkmcnt(15)
  s_add_u32 m0, s77, 49152
  v_mfma_f32_16x16x32_bf16 v[144:147], v[60:63], v[104:107], v[144:147]
  ds_read2_b32 v[174:175], v12 offset0:34 offset1:35
  v_mfma_f32_16x16x32_bf16 v[144:147], v[72:75], v[92:95], v[144:147]
  ds_read_b128 v[204:207], v241 offset:640
  v_mfma_f32_16x16x32_bf16 v[140:143], v[52:55], v[108:111], v[140:143]
  ds_read2_b32 v[176:177], v12 offset0:160 offset1:161
  v_mfma_f32_16x16x32_bf16 v[140:143], v[76:79], v[84:87], v[140:143]
  buffer_load_dwordx4 v228, s[36:39], s71 offen offset:0 lds
  v_mfma_f32_16x16x32_bf16 v[144:147], v[56:59], v[108:111], v[144:147]
  ds_read2_b32 v[178:179], v12 offset0:162 offset1:163
  v_mfma_f32_16x16x32_bf16 v[144:147], v[76:79], v[88:91], v[144:147]
  ds_read_b128 v[208:211], v241 offset:128
  v_mfma_f32_16x16x32_bf16 v[144:147], v[52:55], v[112:115], v[144:147]
  v_mfma_f32_16x16x32_bf16 v[144:147], v[80:83], v[84:87], v[144:147]
  buffer_load_dwordx4 v229, s[36:39], s71 offen offset:1024 lds
  v_mfma_f32_16x16x32_bf16 v[116:119], v[148:151], v[180:183], v[116:119]
  v_mfma_f32_16x16x32_bf16 v[120:123], v[148:151], v[184:187], v[120:123]
  v_mfma_f32_16x16x32_bf16 v[120:123], v[152:155], v[180:183], v[120:123]
  ds_read2_b32 v[52:53], v240 offset0:48 offset1:49
  v_mfma_f32_16x16x32_bf16 v[124:127], v[152:155], v[184:187], v[124:127]
  buffer_load_dwordx4 v230, s[36:39], s71 offen offset:2048 lds
  s_waitcnt lgkmcnt(15)
  v_mfma_f32_16x16x32_bf16 v[124:127], v[148:151], v[188:191], v[124:127]
  ds_read2_b32 v[54:55], v240 offset0:50 offset1:51
  v_mfma_f32_16x16x32_bf16 v[124:127], v[156:159], v[180:183], v[124:127]
  ds_read_b128 v[84:87], v241 offset:3776
  v_mfma_f32_16x16x32_bf16 v[128:131], v[152:155], v[188:191], v[128:131]
  ds_read2_b32 v[56:57], v240 offset0:176 offset1:177
  v_mfma_f32_16x16x32_bf16 v[128:131], v[156:159], v[184:187], v[128:131]
  buffer_load_dwordx4 v231, s[36:39], s71 offen offset:3072 lds
  v_mfma_f32_16x16x32_bf16 v[132:135], v[156:159], v[188:191], v[132:135]
  ds_read2_b32 v[58:59], v240 offset0:178 offset1:179
  s_waitcnt lgkmcnt(15)
  v_mfma_f32_16x16x32_bf16 v[128:131], v[148:151], v[192:195], v[128:131]
  ds_read_b128 v[88:91], v241 offset:3264
  v_mfma_f32_16x16x32_bf16 v[128:131], v[160:163], v[180:183], v[128:131]
  ds_read2_b32 v[60:61], v10 offset0:48 offset1:49
  v_mfma_f32_16x16x32_bf16 v[132:135], v[152:155], v[192:195], v[132:135]
  buffer_load_dwordx4 a[0:3], v232, s[16:19], s84 offen offset:0 sc1
  ds_read_b64_tr_b16 a[224:225], v216 offset:16384
  v_mfma_f32_16x16x32_bf16 v[132:135], v[160:163], v[184:187], v[132:135]
  ds_read2_b32 v[62:63], v10 offset0:50 offset1:51
  ds_read_b64_tr_b16 a[226:227], v216 offset:16896
  v_mfma_f32_16x16x32_bf16 v[136:139], v[156:159], v[192:195], v[136:139]
  ds_read_b128 v[92:95], v241 offset:2752
  ds_read_b64_tr_b16 a[228:229], v217 offset:16384
  v_mfma_f32_16x16x32_bf16 v[136:139], v[160:163], v[188:191], v[136:139]
  ds_read2_b32 v[64:65], v10 offset0:176 offset1:177
  ds_read_b64_tr_b16 a[230:231], v217 offset:16896
  v_mfma_f32_16x16x32_bf16 v[140:143], v[160:163], v[192:195], v[140:143]
  buffer_load_dwordx4 a[4:7], v232, s[16:19], s84 offen offset:1024 sc1
  ds_read_b64_tr_b16 a[232:233], v216 offset:18432
  s_waitcnt lgkmcnt(15)
  v_mfma_f32_16x16x32_bf16 v[132:135], v[148:151], v[196:199], v[132:135]
  ds_read2_b32 v[66:67], v10 offset0:178 offset1:179
  ds_read_b64_tr_b16 a[234:235], v216 offset:18944
  v_mfma_f32_16x16x32_bf16 v[132:135], v[164:167], v[180:183], v[132:135]
  ds_read_b128 v[96:99], v241 offset:2240
  ds_read_b64_tr_b16 a[236:237], v217 offset:18432
  v_mfma_f32_16x16x32_bf16 v[136:139], v[152:155], v[196:199], v[136:139]
  ds_read2_b32 v[68:69], v11 offset0:48 offset1:49
  ds_read_b64_tr_b16 a[238:239], v217 offset:18944
  v_mfma_f32_16x16x32_bf16 v[136:139], v[164:167], v[184:187], v[136:139]
  buffer_load_dwordx4 a[8:11], v232, s[16:19], s84 offen offset:2048 sc1
  v_mfma_f32_16x16x32_bf16 v[140:143], v[156:159], v[196:199], v[140:143]
  ds_read2_b32 v[70:71], v11 offset0:50 offset1:51
  v_mfma_f32_16x16x32_bf16 v[140:143], v[164:167], v[188:191], v[140:143]
  ds_read_b128 v[100:103], v241 offset:1728
  v_mfma_f32_16x16x32_bf16 v[144:147], v[160:163], v[196:199], v[144:147]
  ds_read2_b32 v[72:73], v11 offset0:176 offset1:177
  v_mfma_f32_16x16x32_bf16 v[144:147], v[164:167], v[192:195], v[144:147]
  buffer_load_dwordx4 a[12:15], v232, s[16:19], s84 offen offset:3072 sc1
  v_mfma_f32_16x16x32_bf16 v[136:139], v[148:151], v[200:203], v[136:139]
  ds_read2_b32 v[74:75], v11 offset0:178 offset1:179
  s_lshl_b32 s7, s20, 1
  v_mfma_f32_16x16x32_bf16 v[136:139], v[168:171], v[180:183], v[136:139]
  ds_read_b128 v[104:107], v241 offset:1216
  v_xor_b32 v3, s7, v1
  v_mfma_f32_16x16x32_bf16 v[140:143], v[152:155], v[200:203], v[140:143]
  ds_read2_b32 v[76:77], v12 offset0:48 offset1:49
  v_lshrrev_b32 v2, 3, v1
  v_mfma_f32_16x16x32_bf16 v[140:143], v[168:171], v[184:187], v[140:143]
  buffer_load_dwordx4 a[16:19], v232, s[16:19], s85 offen offset:0 sc1
  v_lshlrev_b32 v2, 12, v2
  v_mfma_f32_16x16x32_bf16 v[144:147], v[156:159], v[200:203], v[144:147]
  ds_read2_b32 v[78:79], v12 offset0:50 offset1:51
  v_and_b32 v3, 7, v3
  v_mfma_f32_16x16x32_bf16 v[144:147], v[168:171], v[188:191], v[144:147]
  ds_read_b128 v[108:111], v241 offset:704
  v_lshl_add_u32 v2, v3, 4, v2
  v_mfma_f32_16x16x32_bf16 v[140:143], v[148:151], v[204:207], v[140:143]
  ds_read2_b32 v[80:81], v12 offset0:176 offset1:177
  v_xor_b32 v3, 16, v2
  v_mfma_f32_16x16x32_bf16 v[140:143], v[172:175], v[180:183], v[140:143]
  buffer_load_dwordx4 a[20:23], v232, s[16:19], s85 offen offset:1024 sc1
  v_add_u32 v3, 31744, v3
  v_mfma_f32_16x16x32_bf16 v[144:147], v[152:155], v[204:207], v[144:147]
  ds_read2_b32 v[82:83], v12 offset0:178 offset1:179
  s_lshl_b32 s3, s54, 18
  v_mfma_f32_16x16x32_bf16 v[144:147], v[172:175], v[184:187], v[144:147]
  ds_read_b128 v[112:115], v241 offset:192
  s_lshl_b32 s7, s20, 16
  v_mfma_f32_16x16x32_bf16 v[144:147], v[148:151], v[208:211], v[144:147]
  s_add_u32 s3, s3, s7
  v_mfma_f32_16x16x32_bf16 v[144:147], v[176:179], v[180:183], v[144:147]
  buffer_load_dwordx4 a[24:27], v232, s[16:19], s85 offen offset:2048 sc1
  s_lshl_b32 s7, s53, 7
  s_waitcnt lgkmcnt(15)
  v_mfma_f32_16x16x32_bf16 v[116:119], v[52:55], v[84:87], v[116:119]
  s_add_u32 s3, s3, s7
  v_mfma_f32_16x16x32_bf16 v[120:123], v[52:55], v[88:91], v[120:123]
  s_add_u32 s3, s3, 9437184
  v_mfma_f32_16x16x32_bf16 v[120:123], v[56:59], v[84:87], v[120:123]
  v_and_b32 v24, 31, v1
  v_mfma_f32_16x16x32_bf16 v[124:127], v[56:59], v[88:91], v[124:127]
  buffer_load_dwordx4 a[28:31], v232, s[16:19], s85 offen offset:3072 sc1
  v_mul_u32_u24 v24, 272, v24
  v_mfma_f32_16x16x32_bf16 v[124:127], v[52:55], v[92:95], v[124:127]
  v_lshrrev_b32 v25, 5, v1
  v_mfma_f32_16x16x32_bf16 v[124:127], v[60:63], v[84:87], v[124:127]
  v_lshl_add_u32 v24, v25, 4, v24
  v_mfma_f32_16x16x32_bf16 v[128:131], v[56:59], v[92:95], v[128:131]
  s_mul_i32 s6, s20, 8704
  v_mfma_f32_16x16x32_bf16 v[128:131], v[60:63], v[88:91], v[128:131]
  buffer_load_dwordx4 a[32:35], v232, s[16:19], s86 offen offset:0 sc1
  s_add_u32 s6, s6, 98304
  v_mfma_f32_16x16x32_bf16 v[132:135], v[60:63], v[92:95], v[132:135]
  v_add_u32 v24, s6, v24
  s_waitcnt lgkmcnt(14)
  v_mfma_f32_16x16x32_bf16 v[128:131], v[52:55], v[96:99], v[128:131]
  v_lshrrev_b32 v25, 5, v1
  v_mfma_f32_16x16x32_bf16 v[128:131], v[64:67], v[84:87], v[128:131]
  v_and_b32 v26, 3, v1
  v_mfma_f32_16x16x32_bf16 v[132:135], v[56:59], v[96:99], v[132:135]
  buffer_load_dwordx4 a[36:39], v232, s[16:19], s86 offen offset:1024 sc1
  v_lshl_add_u32 v25, v25, 2, v26
  v_mfma_f32_16x16x32_bf16 v[132:135], v[64:67], v[88:91], v[132:135]
  v_mul_u32_u24 v25, 272, v25
  v_mfma_f32_16x16x32_bf16 v[136:139], v[60:63], v[96:99], v[136:139]
  v_bfe_u32 v26, v1, 2, 3
  v_mfma_f32_16x16x32_bf16 v[136:139], v[64:67], v[92:95], v[136:139]
  v_lshl_add_u32 v25, v26, 5, v25
  v_mfma_f32_16x16x32_bf16 v[140:143], v[64:67], v[96:99], v[140:143]
  buffer_load_dwordx4 a[40:43], v232, s[16:19], s86 offen offset:2048 sc1
  s_mul_i32 s6, s20, 2176
  s_waitcnt lgkmcnt(9)
  v_mfma_f32_16x16x32_bf16 v[132:135], v[52:55], v[100:103], v[132:135]
  s_add_u32 s6, s6, 98304
  v_mfma_f32_16x16x32_bf16 v[132:135], v[68:71], v[84:87], v[132:135]
  v_add_u32 v25, s6, v25
  v_mfma_f32_16x16x32_bf16 v[136:139], v[56:59], v[100:103], v[136:139]
  v_bfe_u32 v26, v1, 4, 1
  v_mfma_f32_16x16x32_bf16 v[136:139], v[68:71], v[88:91], v[136:139]
  buffer_load_dwordx4 a[44:47], v232, s[16:19], s86 offen offset:3072 sc1
  v_and_b32 v27, 3, v1
  v_mfma_f32_16x16x32_bf16 v[140:143], v[60:63], v[100:103], v[140:143]
  v_lshl_add_u32 v26, v26, 2, v27
  v_mfma_f32_16x16x32_bf16 v[140:143], v[68:71], v[92:95], v[140:143]
  v_xor_b32 v23, s20, v26
  v_mfma_f32_16x16x32_bf16 v[144:147], v[64:67], v[100:103], v[144:147]
  v_bfe_u32 v27, v1, 2, 2
  v_mfma_f32_16x16x32_bf16 v[144:147], v[68:71], v[96:99], v[144:147]
  buffer_load_dwordx4 a[48:51], v232, s[16:19], s87 offen offset:0 sc1
  v_lshl_add_u32 v26, v26, 3, v27
  s_waitcnt lgkmcnt(6)
  v_mfma_f32_16x16x32_bf16 v[136:139], v[52:55], v[104:107], v[136:139]
  v_lshlrev_b32 v26, 7, v26
  v_mfma_f32_16x16x32_bf16 v[136:139], v[72:75], v[84:87], v[136:139]
  v_lshl_add_u32 v26, v23, 4, v26
  v_mfma_f32_16x16x32_bf16 v[140:143], v[56:59], v[104:107], v[140:143]
  v_lshrrev_b32 v27, 5, v1
  v_mfma_f32_16x16x32_bf16 v[140:143], v[72:75], v[88:91], v[140:143]
  buffer_load_dwordx4 a[52:55], v232, s[16:19], s87 offen offset:1024 sc1
  v_lshl_add_u32 v26, v27, 3, v26
  v_mfma_f32_16x16x32_bf16 v[144:147], v[60:63], v[104:107], v[144:147]
  v_xor_b32 v27, 64, v26
  v_mfma_f32_16x16x32_bf16 v[144:147], v[72:75], v[92:95], v[144:147]
  v_add_u32 v26, 133120, v26
  s_waitcnt lgkmcnt(3)
  v_mfma_f32_16x16x32_bf16 v[140:143], v[52:55], v[108:111], v[140:143]
  v_add_u32 v27, 133120, v27
  v_mfma_f32_16x16x32_bf16 v[140:143], v[76:79], v[84:87], v[140:143]
  buffer_load_dwordx4 a[56:59], v232, s[16:19], s87 offen offset:2048 sc1
  s_waitcnt vmcnt(25)
  v_mfma_f32_16x16x32_bf16 v[144:147], v[56:59], v[108:111], v[144:147]
  v_cmp_ne_u32 vcc, s48, v43
  v_mfma_f32_16x16x32_bf16 v[144:147], v[76:79], v[88:91], v[144:147]
  v_cmp_ne_u32 s[4:5], s48, v227
  s_waitcnt lgkmcnt(0)
  v_mfma_f32_16x16x32_bf16 v[144:147], v[52:55], v[112:115], v[144:147]
  s_or_b64 vcc, vcc, s[4:5]
  v_mfma_f32_16x16x32_bf16 v[144:147], v[80:83], v[84:87], v[144:147]
  buffer_load_dwordx4 a[60:63], v232, s[16:19], s87 offen offset:3072 sc1
  s_cbranch_vccnz L_slow_st
L_ok_st:
  s_lshl_b32 s7, s20, 13
  s_add_u32 s7, s7, 98304
  v_add_u32 v4, s7, v31
  s_and_b32 s7, s20, 2
  s_lshl_b32 s7, s7, 13
  s_lshl_b32 s6, s74, 12
  s_add_u32 s7, s7, s6
  s_add_u32 s7, s7, 98304
  v_add_u32 v5, s7, v31
  s_mov_b32 s27, 131072
  buffer_load_dwordx2 v[252:253], v246, s[16:19], s27 offen sc1
  s_barrier
  ds_write_b128 v4, v[116:119] offset:0
  ds_write_b128 v4, v[120:123] offset:1024
  buffer_load_dwordx4 a[64:67], v232, s[16:19], s88 offen offset:0 sc1
  ds_write_b128 v4, v[124:127] offset:2048
  ds_write_b128 v4, v[128:131] offset:3072
  ds_write_b128 v4, v[132:135] offset:4096
  buffer_load_dwordx4 a[68:71], v232, s[16:19], s88 offen offset:1024 sc1
  ds_write_b128 v4, v[136:139] offset:5120
  ds_write_b128 v4, v[140:143] offset:6144
  ds_write_b128 v4, v[144:147] offset:7168
  s_add_u32 m0, s77, 81920
  s_nop 0
  buffer_load_dwordx4 v228, s[36:39], s73 offen offset:0 lds
  s_waitcnt lgkmcnt(0)
  s_barrier
  ds_read_b128 v[116:119], v5 offset:0
  ds_read_b128 v[132:135], v5 offset:8192
  ds_read_b128 v[120:123], v5 offset:1024
  ds_read_b128 v[136:139], v5 offset:9216
  ds_read_b128 v[124:127], v5 offset:2048
  ds_read_b128 v[140:143], v5 offset:10240
  ds_read_b128 v[128:131], v5 offset:3072
  ds_read_b128 v[144:147], v5 offset:11264
  buffer_load_dwordx4 v229, s[36:39], s73 offen offset:1024 lds
  s_waitcnt lgkmcnt(6)
  v_pk_add_f32 v[116:117], v[116:117], v[132:133]
  v_pk_add_f32 v[118:119], v[118:119], v[134:135]
  s_waitcnt lgkmcnt(4)
  v_pk_add_f32 v[120:121], v[120:121], v[136:137]
  v_pk_add_f32 v[122:123], v[122:123], v[138:139]
  s_waitcnt lgkmcnt(2)
  v_pk_add_f32 v[124:125], v[124:125], v[140:141]
  v_pk_add_f32 v[126:127], v[126:127], v[142:143]
  s_waitcnt lgkmcnt(0)
  v_pk_add_f32 v[128:129], v[128:129], v[144:145]
  v_pk_add_f32 v[130:131], v[130:131], v[146:147]
  v_cvt_pk_bf16_f32 v32, v116, v117
  v_cvt_pk_bf16_f32 v33, v118, v119
  v_cvt_pk_bf16_f32 v34, v120, v121
  v_cvt_pk_bf16_f32 v35, v122, v123
  v_cvt_pk_bf16_f32 v36, v124, v125
  v_cvt_pk_bf16_f32 v37, v126, v127
  v_cvt_pk_bf16_f32 v38, v128, v129
  v_cvt_pk_bf16_f32 v39, v130, v131
  buffer_load_dwordx4 v230, s[36:39], s73 offen offset:2048 lds
  s_nop 0
  v_permlane16_swap_b32 v32, v34
  v_permlane16_swap_b32 v33, v35
  v_permlane16_swap_b32 v36, v38
  v_permlane16_swap_b32 v37, v39
  buffer_store_dwordx4 v[32:35], v242, s[16:19], s57 offen offset:0 sc1
  buffer_store_dwordx4 v[36:39], v242, s[16:19], s57 offen offset:1024 sc1
  s_waitcnt vmcnt(22)
  v_mfma_f32_32x32x16_bf16 v[120:135], a[128:131], a[0:3], 0
  v_and_b32 v40, 0xffff0000, v40
  v_mul_f32 v41, 0xbf317218, v42
  v_lshlrev_b32 v12, 16, v44
  v_and_b32 v13, 0xffff0000, v44
  v_lshlrev_b32 v14, 16, v45
  v_and_b32 v15, 0xffff0000, v45
  v_mfma_f32_32x32x16_bf16 v[136:151], a[132:135], a[0:3], 0
  v_lshlrev_b32 v16, 16, v46
  v_and_b32 v17, 0xffff0000, v46
  v_lshlrev_b32 v18, 16, v47
  v_and_b32 v19, 0xffff0000, v47
  v_mul_f32 v40, v40, v41
  v_fma_f32 v32, v12, v41, v40
  v_mfma_f32_32x32x16_bf16 v[120:135], a[136:139], a[4:7], v[120:135]
  v_fma_f32 v33, v13, v41, v40
  v_fma_f32 v34, v14, v41, v40
  v_fma_f32 v35, v15, v41, v40
  v_fma_f32 v36, v16, v41, v40
  v_fma_f32 v37, v17, v41, v40
  v_fma_f32 v38, v18, v41, v40
  v_mfma_f32_32x32x16_bf16 v[136:151], a[140:143], a[4:7], v[136:151]
  v_fma_f32 v39, v19, v41, v40
  s_mov_b32 s4, 0xbfb8aa3b
  s_mov_b32 s5, s4
  s_waitcnt vmcnt(20)
  v_mfma_f32_32x32x16_bf16 v[120:135], a[144:147], a[8:11], v[120:135]
  v_mfma_f32_32x32x16_bf16 v[136:151], a[148:151], a[8:11], v[136:151]
  v_mfma_f32_32x32x16_bf16 v[120:135], a[152:155], a[12:15], v[120:135]
  v_mfma_f32_32x32x16_bf16 v[136:151], a[156:159], a[12:15], v[136:151]
  s_waitcnt vmcnt(18)
  v_mfma_f32_32x32x16_bf16 v[120:135], a[160:163], a[16:19], v[120:135]
  v_mfma_f32_32x32x16_bf16 v[136:151], a[164:167], a[16:19], v[136:151]
  v_mfma_f32_32x32x16_bf16 v[120:135], a[168:171], a[20:23], v[120:135]
  v_mfma_f32_32x32x16_bf16 v[136:151], a[172:175], a[20:23], v[136:151]
  s_waitcnt vmcnt(16)
  v_mfma_f32_32x32x16_bf16 v[120:135], a[176:179], a[24:27], v[120:135]
  v_mfma_f32_32x32x16_bf16 v[136:151], a[180:183], a[24:27], v[136:151]
  v_mfma_f32_32x32x16_bf16 v[120:135], a[184:187], a[28:31], v[120:135]
  v_mfma_f32_32x32x16_bf16 v[136:151], a[188:191], a[28:31], v[136:151]
  s_waitcnt vmcnt(14)
  v_mfma_f32_32x32x16_bf16 v[120:135], a[192:195], a[32:35], v[120:135]
  buffer_load_dwordx4 v231, s[36:39], s73 offen offset:3072 lds
  v_mfma_f32_32x32x16_bf16 v[136:151], a[196:199], a[32:35], v[136:151]
  buffer_load_dwordx4 a[72:75], v232, s[16:19], s88 offen offset:2048 sc1
  v_mfma_f32_32x32x16_bf16 v[120:135], a[200:203], a[36:39], v[120:135]
  buffer_load_dwordx4 a[76:79], v232, s[16:19], s88 offen offset:3072 sc1
  v_mfma_f32_32x32x16_bf16 v[136:151], a[204:207], a[36:39], v[136:151]
  s_waitcnt vmcnt(10)
  v_cmp_ne_u64 vcc, s[48:49], v[252:253]
  s_cbranch_vccnz L_slow_hB
L_ok_hB:
  v_mfma_f32_32x32x16_bf16 v[120:135], a[208:211], a[40:43], v[120:135]
  buffer_load_dwordx4 a[80:83], v232, s[16:19], s89 offen offset:0 sc1
  v_mfma_f32_32x32x16_bf16 v[136:151], a[212:215], a[40:43], v[136:151]
  buffer_load_dwordx4 a[84:87], v232, s[16:19], s89 offen offset:1024 sc1
  v_mfma_f32_32x32x16_bf16 v[120:135], a[216:219], a[44:47], v[120:135]
  v_mfma_f32_32x32x16_bf16 v[136:151], a[220:223], a[44:47], v[136:151]
  s_waitcnt vmcnt(5)
  s_barrier
  buffer_store_dwordx2 v[6:7], v9, s[16:19], s59 offen sc1
  v_mfma_f32_32x32x16_bf16 v[120:135], a[224:227], a[48:51], v[120:135]
  buffer_load_dwordx4 a[88:91], v232, s[16:19], s89 offen offset:2048 sc1
  ds_read_b64_tr_b16 a[240:241], v220 offset:10240
  ds_read_b64_tr_b16 a[242:243], v220 offset:10752
  v_mfma_f32_32x32x16_bf16 v[136:151], a[228:231], a[48:51], v[136:151]
  buffer_load_dwordx4 a[92:95], v232, s[16:19], s89 offen offset:3072 sc1
  ds_read_b64_tr_b16 a[244:245], v221 offset:10240
  ds_read_b64_tr_b16 a[246:247], v221 offset:10752
  v_mfma_f32_32x32x16_bf16 v[120:135], a[232:235], a[52:55], v[120:135]
  ds_read_b64_tr_b16 a[248:249], v220 offset:12288
  ds_read_b64_tr_b16 a[250:251], v220 offset:12800
  v_mfma_f32_32x32x16_bf16 v[136:151], a[236:239], a[52:55], v[136:151]
  ds_read_b64_tr_b16 a[252:253], v221 offset:12288
  ds_read_b64_tr_b16 a[254:255], v221 offset:12800
  s_waitcnt lgkmcnt(0)
  v_mfma_f32_32x32x16_bf16 v[120:135], a[240:243], a[56:59], v[120:135]
  buffer_load_dwordx4 a[96:99], v232, s[16:19], s90 offen offset:0 sc1
  ds_read_b64_tr_b16 v[184:185], v236 offset:0
  ds_read_b64_tr_b16 v[186:187], v236 offset:512
  v_mfma_f32_32x32x16_bf16 v[136:151], a[244:247], a[56:59], v[136:151]
  buffer_load_dwordx4 a[100:103], v232, s[16:19], s90 offen offset:1024 sc1
  ds_read_b64_tr_b16 v[188:189], v237 offset:0
  ds_read_b64_tr_b16 v[190:191], v237 offset:512
  v_mfma_f32_32x32x16_bf16 v[120:135], a[248:251], a[60:63], v[120:135]
  ds_read_b64_tr_b16 v[192:193], v236 offset:2048
  ds_read_b64_tr_b16 v[194:195], v236 offset:2560
  v_mfma_f32_32x32x16_bf16 v[136:151], a[252:255], a[60:63], v[136:151]
  ds_read_b64_tr_b16 v[196:197], v237 offset:2048
  ds_read_b64_tr_b16 v[198:199], v237 offset:2560
  s_waitcnt lgkmcnt(0)
  v_mfma_f32_32x32x16_bf16 v[120:135], v[184:187], a[64:67], v[120:135]
  buffer_load_dwordx4 a[104:107], v232, s[16:19], s90 offen offset:2048 sc1
  ds_read_b64_tr_b16 v[200:201], v236 offset:16384
  ds_read_b64_tr_b16 v[202:203], v236 offset:16896
  v_mfma_f32_32x32x16_bf16 v[136:151], v[188:191], a[64:67], v[136:151]
  buffer_load_dwordx4 a[108:111], v232, s[16:19], s90 offen offset:3072 sc1
  ds_read_b64_tr_b16 v[204:205], v237 offset:16384
  ds_read_b64_tr_b16 v[206:207], v237 offset:16896
  v_mfma_f32_32x32x16_bf16 v[120:135], v[192:195], a[68:71], v[120:135]
  ds_read_b64_tr_b16 v[208:209], v236 offset:18432
  ds_read_b64_tr_b16 v[210:211], v236 offset:18944
  v_mfma_f32_32x32x16_bf16 v[136:151], v[196:199], a[68:71], v[136:151]
  ds_read_b64_tr_b16 v[212:213], v237 offset:18432
  ds_read_b64_tr_b16 v[214:215], v237 offset:18944
  s_waitcnt vmcnt(9) lgkmcnt(0)
  v_mfma_f32_32x32x16_bf16 v[120:135], v[200:203], a[72:75], v[120:135]
  buffer_load_dwordx4 a[112:115], v233, s[16:19], s84 offen offset:0 sc1
  ds_read_b64_tr_b16 v[56:57], v236 offset:32768
  ds_read_b64_tr_b16 v[58:59], v236 offset:33280
  v_mfma_f32_32x32x16_bf16 v[136:151], v[204:207], a[72:75], v[136:151]
  buffer_load_dwordx4 a[116:119], v233, s[16:19], s84 offen offset:1024 sc1
  ds_read_b64_tr_b16 v[60:61], v237 offset:32768
  ds_read_b64_tr_b16 v[62:63], v237 offset:33280
  v_mfma_f32_32x32x16_bf16 v[120:135], v[208:211], a[76:79], v[120:135]
  ds_read_b64_tr_b16 v[64:65], v236 offset:34816
  ds_read_b64_tr_b16 v[66:67], v236 offset:35328
  v_mfma_f32_32x32x16_bf16 v[136:151], v[212:215], a[76:79], v[136:151]
  ds_read_b64_tr_b16 v[68:69], v237 offset:34816
  ds_read_b64_tr_b16 v[70:71], v237 offset:35328
  s_waitcnt vmcnt(9) lgkmcnt(0)
  v_mfma_f32_32x32x16_bf16 v[120:135], v[56:59], a[80:83], v[120:135]
  buffer_load_dwordx4 a[120:123], v233, s[16:19], s84 offen offset:2048 sc1
  ds_read_b64_tr_b16 v[72:73], v236 offset:49152
  ds_read_b64_tr_b16 v[74:75], v236 offset:49664
  v_mfma_f32_32x32x16_bf16 v[136:151], v[60:63], a[80:83], v[136:151]
  buffer_load_dwordx4 a[124:127], v233, s[16:19], s84 offen offset:3072 sc1
  ds_read_b64_tr_b16 v[76:77], v237 offset:49152
  ds_read_b64_tr_b16 v[78:79], v237 offset:49664
  v_mfma_f32_32x32x16_bf16 v[120:135], v[64:67], a[84:87], v[120:135]
  ds_read_b64_tr_b16 v[80:81], v236 offset:51200
  ds_read_b64_tr_b16 v[82:83], v236 offset:51712
  v_mfma_f32_32x32x16_bf16 v[136:151], v[68:71], a[84:87], v[136:151]
  ds_read_b64_tr_b16 v[84:85], v237 offset:51200
  ds_read_b64_tr_b16 v[86:87], v237 offset:51712
  s_waitcnt vmcnt(8) lgkmcnt(0)
  v_mfma_f32_32x32x16_bf16 v[120:135], v[72:75], a[88:91], v[120:135]
  buffer_load_dwordx4 a[0:3], v233, s[16:19], s85 offen offset:0 sc1
  ds_read_b64_tr_b16 v[88:89], v216 offset:0
  ds_read_b64_tr_b16 v[90:91], v216 offset:512
  v_mfma_f32_32x32x16_bf16 v[136:151], v[76:79], a[88:91], v[136:151]
  buffer_load_dwordx4 a[4:7], v233, s[16:19], s85 offen offset:1024 sc1
  ds_read_b64_tr_b16 v[92:93], v217 offset:0
  ds_read_b64_tr_b16 v[94:95], v217 offset:512
  v_mfma_f32_32x32x16_bf16 v[120:135], v[80:83], a[92:95], v[120:135]
  ds_read_b64_tr_b16 v[96:97], v216 offset:2048
  ds_read_b64_tr_b16 v[98:99], v216 offset:2560
  v_mfma_f32_32x32x16_bf16 v[136:151], v[84:87], a[92:95], v[136:151]
  ds_read_b64_tr_b16 v[100:101], v217 offset:2048
  ds_read_b64_tr_b16 v[102:103], v217 offset:2560
  s_waitcnt vmcnt(8) lgkmcnt(0)
  v_mfma_f32_32x32x16_bf16 v[120:135], v[88:91], a[96:99], v[120:135]
  buffer_load_dwordx4 a[8:11], v233, s[16:19], s85 offen offset:2048 sc1
  ds_read_b64_tr_b16 v[104:105], v216 offset:16384
  ds_read_b64_tr_b16 v[106:107], v216 offset:16896
  v_mfma_f32_32x32x16_bf16 v[136:151], v[92:95], a[96:99], v[136:151]
  buffer_load_dwordx4 a[12:15], v233, s[16:19], s85 offen offset:3072 sc1
  ds_read_b64_tr_b16 v[108:109], v217 offset:16384
  ds_read_b64_tr_b16 v[110:111], v217 offset:16896
  v_mfma_f32_32x32x16_bf16 v[120:135], v[96:99], a[100:103], v[120:135]
  ds_read_b64_tr_b16 v[112:113], v216 offset:18432
  ds_read_b64_tr_b16 v[114:115], v216 offset:18944
  v_mfma_f32_32x32x16_bf16 v[136:151], v[100:103], a[100:103], v[136:151]
  ds_read_b64_tr_b16 v[116:117], v217 offset:18432
  ds_read_b64_tr_b16 v[118:119], v217 offset:18944
  s_waitcnt vmcnt(8) lgkmcnt(0)
  v_mfma_f32_32x32x16_bf16 v[120:135], v[104:107], a[104:107], v[120:135]
  buffer_load_dwordx4 a[16:19], v233, s[16:19], s86 offen offset:0 sc1
  v_mfma_f32_32x32x16_bf16 v[136:151], v[108:111], a[104:107], v[136:151]
  buffer_load_dwordx4 a[20:23], v233, s[16:19], s86 offen offset:1024 sc1
  v_mfma_f32_32x32x16_bf16 v[120:135], v[112:115], a[108:111], v[120:135]
  v_mfma_f32_32x32x16_bf16 v[136:151], v[116:119], a[108:111], v[136:151]
  s_waitcnt vmcnt(8)
  v_mfma_f32_32x32x16_bf16 v[152:167], a[128:131], a[112:115], 0
  buffer_load_dwordx4 a[24:27], v233, s[16:19], s86 offen offset:2048 sc1
  v_mfma_f32_32x32x16_bf16 v[168:183], a[132:135], a[112:115], 0
  buffer_load_dwordx4 a[28:31], v233, s[16:19], s86 offen offset:3072 sc1
  v_mfma_f32_32x32x16_bf16 v[152:167], a[136:139], a[116:119], v[152:167]
  v_mfma_f32_32x32x16_bf16 v[168:183], a[140:143], a[116:119], v[168:183]
  s_waitcnt vmcnt(8)
  v_mfma_f32_32x32x16_bf16 v[152:167], a[144:147], a[120:123], v[152:167]
  buffer_load_dwordx4 a[32:35], v233, s[16:19], s87 offen offset:0 sc1
  v_mfma_f32_32x32x16_bf16 v[168:183], a[148:151], a[120:123], v[168:183]
  buffer_load_dwordx4 a[36:39], v233, s[16:19], s87 offen offset:1024 sc1
  ds_write_b128 v24, v[120:123] offset:0
  v_mfma_f32_32x32x16_bf16 v[152:167], a[152:155], a[124:127], v[152:167]
  ds_write_b128 v24, v[124:127] offset:32
  v_mfma_f32_32x32x16_bf16 v[168:183], a[156:159], a[124:127], v[168:183]
  ds_write_b128 v24, v[128:131] offset:64
  s_waitcnt vmcnt(8)
  v_mfma_f32_32x32x16_bf16 v[152:167], a[160:163], a[0:3], v[152:167]
  buffer_load_dwordx4 a[40:43], v233, s[16:19], s87 offen offset:2048 sc1
  ds_write_b128 v24, v[132:135] offset:96
  v_mfma_f32_32x32x16_bf16 v[168:183], a[164:167], a[0:3], v[168:183]
  buffer_load_dwordx4 a[44:47], v233, s[16:19], s87 offen offset:3072 sc1
  ds_write_b128 v24, v[136:139] offset:128
  v_mfma_f32_32x32x16_bf16 v[152:167], a[168:171], a[4:7], v[152:167]
  ds_write_b128 v24, v[140:143] offset:160
  v_mfma_f32_32x32x16_bf16 v[168:183], a[172:175], a[4:7], v[168:183]
  ds_write_b128 v24, v[144:147] offset:192
  s_waitcnt vmcnt(8)
  v_mfma_f32_32x32x16_bf16 v[152:167], a[176:179], a[8:11], v[152:167]
  buffer_load_dwordx4 a[48:51], v233, s[16:19], s88 offen offset:0 sc1
  ds_write_b128 v24, v[148:151] offset:224
  v_mfma_f32_32x32x16_bf16 v[168:183], a[180:183], a[8:11], v[168:183]
  buffer_load_dwordx4 a[52:55], v233, s[16:19], s88 offen offset:1024 sc1
  v_mfma_f32_32x32x16_bf16 v[152:167], a[184:187], a[12:15], v[152:167]
  v_mfma_f32_32x32x16_bf16 v[168:183], a[188:191], a[12:15], v[168:183]
  s_waitcnt vmcnt(8)
  v_mfma_f32_32x32x16_bf16 v[152:167], a[192:195], a[16:19], v[152:167]
  buffer_load_dwordx4 a[56:59], v233, s[16:19], s88 offen offset:2048 sc1
  s_waitcnt lgkmcnt(0)
  s_barrier
  ds_read_b128 v[120:123], v25 offset:0
  ds_read_b128 v[128:131], v25 offset:8704
  ds_read_b128 v[136:139], v25 offset:17408
  v_mfma_f32_32x32x16_bf16 v[168:183], a[196:199], a[16:19], v[168:183]
  buffer_load_dwordx4 a[60:63], v233, s[16:19], s88 offen offset:3072 sc1
  ds_read_b128 v[144:147], v25 offset:26112
  ds_read_b128 v[124:127], v25 offset:16
  ds_read_b128 v[132:135], v25 offset:8720
  ds_read_b128 v[140:143], v25 offset:17424
  ds_read_b128 v[148:151], v25 offset:26128
  v_mfma_f32_32x32x16_bf16 v[152:167], a[200:203], a[20:23], v[152:167]
  v_mfma_f32_32x32x16_bf16 v[168:183], a[204:207], a[20:23], v[168:183]
  s_waitcnt vmcnt(8)
  v_mfma_f32_32x32x16_bf16 v[152:167], a[208:211], a[24:27], v[152:167]
  buffer_load_dwordx4 a[64:67], v233, s[16:19], s89 offen offset:0 sc1
  v_mfma_f32_32x32x16_bf16 v[168:183], a[212:215], a[24:27], v[168:183]
  buffer_load_dwordx4 a[68:71], v233, s[16:19], s89 offen offset:1024 sc1
  v_mfma_f32_32x32x16_bf16 v[152:167], a[216:219], a[28:31], v[152:167]
  s_waitcnt lgkmcnt(0)
  v_add_f32 v120, v120, v128
  v_add_f32 v121, v121, v129
  v_add_f32 v122, v122, v130
  v_add_f32 v123, v123, v131
  v_add_f32 v124, v124, v132
  v_mfma_f32_32x32x16_bf16 v[168:183], a[220:223], a[28:31], v[168:183]
  v_add_f32 v125, v125, v133
  v_add_f32 v126, v126, v134
  v_add_f32 v127, v127, v135
  v_add_f32 v136, v136, v144
  v_add_f32 v137, v137, v145
  buffer_load_dwordx2 v[250:251], v243, s[16:19], 0 offen sc1
  s_waitcnt vmcnt(9)
  v_mfma_f32_32x32x16_bf16 v[152:167], a[224:227], a[32:35], v[152:167]
  buffer_load_dwordx4 a[72:75], v233, s[16:19], s89 offen offset:2048 sc1
  v_add_f32 v138, v138, v146
  v_add_f32 v139, v139, v147
  v_add_f32 v140, v140, v148
  v_add_f32 v141, v141, v149
  v_add_f32 v142, v142, v150
  v_mfma_f32_32x32x16_bf16 v[168:183], a[228:231], a[32:35], v[168:183]
  buffer_load_dwordx4 a[76:79], v233, s[16:19], s89 offen offset:3072 sc1
  v_add_f32 v143, v143, v151
  v_add_f32 v120, v120, v136
  v_add_f32 v121, v121, v137
  v_add_f32 v122, v122, v138
  v_add_f32 v123, v123, v139
  v_mfma_f32_32x32x16_bf16 v[152:167], a[232:235], a[36:39], v[152:167]
  v_add_f32 v124, v124, v140
  v_add_f32 v125, v125, v141
  v_add_f32 v126, v126, v142
  v_add_f32 v127, v127, v143
  v_mul_f32 v28, s4, v120
  v_mul_f32 v29, s4, v121
  v_mfma_f32_32x32x16_bf16 v[168:183], a[236:239], a[36:39], v[168:183]
  v_mul_f32 v30, s4, v122
  v_mul_f32 v31, s4, v123
  v_mul_f32 v218, s4, v124
  v_mul_f32 v219, s4, v125
  v_mul_f32 v222, s4, v126
  s_waitcnt vmcnt(9)
  v_mfma_f32_32x32x16_bf16 v[152:167], a[240:243], a[40:43], v[152:167]
  buffer_load_dwordx4 a[80:83], v233, s[16:19], s90 offen offset:0 sc1
  v_mul_f32 v223, s4, v127
  v_exp_f32 v28, v28
  v_mul_f32 v32, v32, v120
  v_mfma_f32_32x32x16_bf16 v[168:183], a[244:247], a[40:43], v[168:183]
  buffer_load_dwordx4 a[84:87], v233, s[16:19], s90 offen offset:1024 sc1
  v_exp_f32 v29, v29
  v_mul_f32 v33, v33, v121
  v_exp_f32 v30, v30
  v_mfma_f32_32x32x16_bf16 v[152:167], a[248:251], a[44:47], v[152:167]
  v_mul_f32 v34, v34, v122
  v_exp_f32 v31, v31
  v_mul_f32 v35, v35, v123
  v_exp_f32 v218, v218
  v_mfma_f32_32x32x16_bf16 v[168:183], a[252:255], a[44:47], v[168:183]
  v_mul_f32 v36, v36, v124
  v_exp_f32 v219, v219
  v_mul_f32 v37, v37, v125
  s_waitcnt vmcnt(9)
  v_mfma_f32_32x32x16_bf16 v[152:167], v[184:187], a[48:51], v[152:167]
  buffer_load_dwordx4 a[88:91], v233, s[16:19], s90 offen offset:2048 sc1
  v_exp_f32 v222, v222
  v_mul_f32 v38, v38, v126
  v_exp_f32 v223, v223
  v_mfma_f32_32x32x16_bf16 v[168:183], v[188:191], a[48:51], v[168:183]
  buffer_load_dwordx4 a[92:95], v233, s[16:19], s90 offen offset:3072 sc1
  v_mul_f32 v39, v39, v127
  v_add_f32 v28, 1.0, v28
  v_add_f32 v29, 1.0, v29
  v_add_f32 v30, 1.0, v30
  v_add_f32 v31, 1.0, v31
  v_mfma_f32_32x32x16_bf16 v[152:167], v[192:195], a[52:55], v[152:167]
  v_add_f32 v218, 1.0, v218
  v_add_f32 v219, 1.0, v219
  v_add_f32 v222, 1.0, v222
  v_add_f32 v223, 1.0, v223
  v_rcp_f32 v28, v28
  v_mfma_f32_32x32x16_bf16 v[168:183], v[196:199], a[52:55], v[168:183]
  v_rcp_f32 v29, v29
  v_rcp_f32 v30, v30
  s_waitcnt vmcnt(9)
  v_mfma_f32_32x32x16_bf16 v[152:167], v[200:203], a[56:59], v[152:167]
  v_rcp_f32 v31, v31
  v_rcp_f32 v218, v218
  v_rcp_f32 v219, v219
  v_mfma_f32_32x32x16_bf16 v[168:183], v[204:207], a[56:59], v[168:183]
  v_rcp_f32 v222, v222
  v_rcp_f32 v223, v223
  s_nop 0
  v_mul_f32 v32, v32, v28
  v_mfma_f32_32x32x16_bf16 v[152:167], v[208:211], a[60:63], v[152:167]
  v_mul_f32 v33, v33, v29
  v_mul_f32 v34, v34, v30
  v_mul_f32 v35, v35, v31
  v_mul_f32 v36, v36, v218
  v_mul_f32 v37, v37, v219
  v_mul_f32 v38, v38, v222
  v_mfma_f32_32x32x16_bf16 v[168:183], v[212:215], a[60:63], v[168:183]
  v_mul_f32 v39, v39, v223
  s_waitcnt vmcnt(6)
  v_cmp_ne_u64 vcc, s[48:49], v[250:251]
  s_cbranch_vccnz L_slow_y
L_ok_y:
  s_lshl_b32 s7, s20, 11
  s_add_u32 m0, s7, 133120
  s_nop 0
  buffer_load_dwordx4 v2, s[16:19], s3 offen offset:0 sc1 lds
  buffer_load_dwordx4 v3, s[16:19], s3 offen offset:1024 sc1 lds
  v_mfma_f32_32x32x16_bf16 v[152:167], v[56:59], a[64:67], v[152:167]
  v_mfma_f32_32x32x16_bf16 v[168:183], v[60:63], a[64:67], v[168:183]
  v_mfma_f32_32x32x16_bf16 v[152:167], v[64:67], a[68:71], v[152:167]
  v_mfma_f32_32x32x16_bf16 v[168:183], v[68:71], a[68:71], v[168:183]
  s_waitcnt vmcnt(6)
  v_mfma_f32_32x32x16_bf16 v[152:167], v[72:75], a[72:75], v[152:167]
  v_mfma_f32_32x32x16_bf16 v[168:183], v[76:79], a[72:75], v[168:183]
  v_mfma_f32_32x32x16_bf16 v[152:167], v[80:83], a[76:79], v[152:167]
  v_mfma_f32_32x32x16_bf16 v[168:183], v[84:87], a[76:79], v[168:183]
  s_waitcnt vmcnt(4)
  v_mfma_f32_32x32x16_bf16 v[152:167], v[88:91], a[80:83], v[152:167]
  v_mfma_f32_32x32x16_bf16 v[168:183], v[92:95], a[80:83], v[168:183]
  v_mfma_f32_32x32x16_bf16 v[152:167], v[96:99], a[84:87], v[152:167]
  v_mfma_f32_32x32x16_bf16 v[168:183], v[100:103], a[84:87], v[168:183]
  s_waitcnt vmcnt(2)
  v_mfma_f32_32x32x16_bf16 v[152:167], v[104:107], a[88:91], v[152:167]
  v_mfma_f32_32x32x16_bf16 v[168:183], v[108:111], a[88:91], v[168:183]
  v_mfma_f32_32x32x16_bf16 v[152:167], v[112:115], a[92:95], v[152:167]
  v_mfma_f32_32x32x16_bf16 v[168:183], v[116:119], a[92:95], v[168:183]
  v_add_u32 v24, 4294868992, v24
  v_add_u32 v25, 4294868992, v25
  v_and_b32 v224, 0xffff0000, v224
  v_mul_f32 v225, 0xbf317218, v226
  v_lshlrev_b32 v56, 16, v48
  v_and_b32 v57, 0xffff0000, v48
  v_lshlrev_b32 v58, 16, v49
  v_and_b32 v59, 0xffff0000, v49
  v_lshlrev_b32 v60, 16, v50
  v_and_b32 v61, 0xffff0000, v50
  v_lshlrev_b32 v62, 16, v51
  v_and_b32 v63, 0xffff0000, v51
  v_mul_f32 v224, v224, v225
  v_pk_fma_f32 v[64:65], v[56:57], v[224:225], v[224:225] op_sel:[0,1,0] op_sel_hi:[1,1,0]
  ds_write_b128 v24, v[152:155] offset:0
  v_pk_fma_f32 v[66:67], v[58:59], v[224:225], v[224:225] op_sel:[0,1,0] op_sel_hi:[1,1,0]
  v_pk_fma_f32 v[68:69], v[60:61], v[224:225], v[224:225] op_sel:[0,1,0] op_sel_hi:[1,1,0]
  v_pk_fma_f32 v[70:71], v[62:63], v[224:225], v[224:225] op_sel:[0,1,0] op_sel_hi:[1,1,0]
  ds_write_b128 v24, v[156:159] offset:32
  ds_write_b128 v24, v[160:163] offset:64
  ds_write_b128 v24, v[164:167] offset:96
  ds_write_b128 v24, v[168:171] offset:128
  ds_write_b128 v24, v[172:175] offset:160
  ds_write_b128 v24, v[176:179] offset:192
  ds_write_b128 v24, v[180:183] offset:224
  s_waitcnt vmcnt(0) lgkmcnt(0)
  s_barrier
  ds_read_b64_tr_b16 v[20:21], v26 offset:0
  ds_read_b64_tr_b16 v[22:23], v26 offset:512
  ds_read_b128 v[152:155], v25 offset:0
  ds_read_b128 v[160:163], v25 offset:8704
  ds_read_b128 v[168:171], v25 offset:17408
  ds_read_b128 v[176:179], v25 offset:26112
  ds_read_b128 v[156:159], v25 offset:16
  ds_read_b128 v[164:167], v25 offset:8720
  ds_read_b128 v[172:175], v25 offset:17424
  ds_read_b128 v[180:183], v25 offset:26128
  ds_read_b64_tr_b16 v[80:81], v27 offset:0
  ds_read_b64_tr_b16 v[82:83], v27 offset:512
  s_waitcnt lgkmcnt(10)
  v_lshlrev_b32 v28, 16, v20
  v_and_b32 v29, 0xffff0000, v20
  v_lshlrev_b32 v30, 16, v21
  v_and_b32 v31, 0xffff0000, v21
  v_lshlrev_b32 v218, 16, v22
  v_and_b32 v219, 0xffff0000, v22
  v_lshlrev_b32 v222, 16, v23
  v_and_b32 v223, 0xffff0000, v23
  v_pk_fma_f32 v[12:13], v[32:33], v[28:29], v[12:13]
  v_pk_fma_f32 v[14:15], v[34:35], v[30:31], v[14:15]
  v_pk_fma_f32 v[16:17], v[36:37], v[218:219], v[16:17]
  v_pk_fma_f32 v[18:19], v[38:39], v[222:223], v[18:19]
  v_cvt_pk_bf16_f32 v44, v12, v13
  v_cvt_pk_bf16_f32 v45, v14, v15
  v_cvt_pk_bf16_f32 v46, v16, v17
  v_cvt_pk_bf16_f32 v47, v18, v19
  buffer_store_dwordx4 v[44:47], v244, s[44:47], 0 offen sc1
  s_waitcnt lgkmcnt(2)
  v_pk_add_f32 v[152:153], v[152:153], v[160:161]
  v_pk_add_f32 v[154:155], v[154:155], v[162:163]
  v_pk_add_f32 v[156:157], v[156:157], v[164:165]
  v_pk_add_f32 v[158:159], v[158:159], v[166:167]
  v_pk_add_f32 v[168:169], v[168:169], v[176:177]
  v_pk_add_f32 v[170:171], v[170:171], v[178:179]
  v_pk_add_f32 v[172:173], v[172:173], v[180:181]
  v_pk_add_f32 v[174:175], v[174:175], v[182:183]
  v_pk_add_f32 v[152:153], v[152:153], v[168:169]
  v_pk_add_f32 v[154:155], v[154:155], v[170:171]
  v_pk_add_f32 v[156:157], v[156:157], v[172:173]
  v_pk_add_f32 v[158:159], v[158:159], v[174:175]
  v_pk_mul_f32 v[72:73], s[4:5], v[152:153]
  v_pk_mul_f32 v[74:75], s[4:5], v[154:155]
  v_pk_mul_f32 v[76:77], s[4:5], v[156:157]
  v_pk_mul_f32 v[78:79], s[4:5], v[158:159]
  v_exp_f32 v72, v72
  v_exp_f32 v73, v73
  v_exp_f32 v74, v74
  v_exp_f32 v75, v75
  v_exp_f32 v76, v76
  v_exp_f32 v77, v77
  v_exp_f32 v78, v78
  v_exp_f32 v79, v79
  v_pk_mul_f32 v[64:65], v[64:65], v[152:153]
  v_pk_mul_f32 v[66:67], v[66:67], v[154:155]
  v_pk_mul_f32 v[68:69], v[68:69], v[156:157]
  v_pk_mul_f32 v[70:71], v[70:71], v[158:159]
  v_pk_add_f32 v[72:73], 1.0, v[72:73] op_sel_hi:[0,1]
  v_pk_add_f32 v[74:75], 1.0, v[74:75] op_sel_hi:[0,1]
  v_pk_add_f32 v[76:77], 1.0, v[76:77] op_sel_hi:[0,1]
  v_pk_add_f32 v[78:79], 1.0, v[78:79] op_sel_hi:[0,1]
  v_rcp_f32 v72, v72
  v_rcp_f32 v73, v73
  v_rcp_f32 v74, v74
  v_rcp_f32 v75, v75
  v_rcp_f32 v76, v76
  v_rcp_f32 v77, v77
  v_rcp_f32 v78, v78
  v_rcp_f32 v79, v79
  s_nop 0
  v_pk_mul_f32 v[64:65], v[64:65], v[72:73]
  v_pk_mul_f32 v[66:67], v[66:67], v[74:75]
  v_pk_mul_f32 v[68:69], v[68:69], v[76:77]
  v_pk_mul_f32 v[70:71], v[70:71], v[78:79]
  s_waitcnt lgkmcnt(0)
  v_lshlrev_b32 v72, 16, v80
  v_and_b32 v73, 0xffff0000, v80
  v_lshlrev_b32 v74, 16, v81
  v_and_b32 v75, 0xffff0000, v81
  v_lshlrev_b32 v76, 16, v82
  v_and_b32 v77, 0xffff0000, v82
  v_lshlrev_b32 v78, 16, v83
  v_and_b32 v79, 0xffff0000, v83
  v_pk_fma_f32 v[56:57], v[64:65], v[72:73], v[56:57]
  v_pk_fma_f32 v[58:59], v[66:67], v[74:75], v[58:59]
  v_pk_fma_f32 v[60:61], v[68:69], v[76:77], v[60:61]
  v_pk_fma_f32 v[62:63], v[70:71], v[78:79], v[62:63]
  v_cvt_pk_bf16_f32 v48, v56, v57
  v_cvt_pk_bf16_f32 v49, v58, v59
  v_cvt_pk_bf16_f32 v50, v60, v61
  v_cvt_pk_bf16_f32 v51, v62, v63
  buffer_store_dwordx4 v[48:51], v244, s[44:47], s26 offen sc1
L_end:
s_endpgm
L_aux:
  v_and_b32 v1, 63, v0
  v_lshrrev_b32 v2, 6, v0
  v_lshlrev_b32 v31, 4, v1
  v_readfirstlane_b32 s20, v2
  v_lshrrev_b32 v2, 3, v1
  v_and_b32 v3, 7, v1
  v_lshrrev_b32 v9, 4, v1
  v_mov_b32 v34, 0
  s_lshl_b32 s3, s2, 6
  s_lshl_b32 s4, s20, 4
  s_add_u32 s3, s3, s4
  v_add_u32 v12, s3, v2
  v_lshlrev_b32 v10, 10, v12
  v_lshl_add_u32 v10, v3, 4, v10
  v_add_u32 v11, 8192, v10
  v_mov_b32 v13, v3
  s_memrealtime s[48:49]
  s_waitcnt lgkmcnt(0)
  s_mov_b32 s32, s74
  s_mov_b32 s33, s75
  s_lshr_b32 s3, s2, 3
  s_or_b32 s3, s3, s20
  s_cmp_lg_u32 s3, 0
  s_cselect_b64 exec, 0, 1
  s_or_b32 s48, s48, 1
  v_mov_b32 v16, s48
  v_mov_b32 v17, s49
  v_mov_b32 v18, 0
  v_mov_b32 v19, 0
  s_cbranch_execz L_aux_nt
  global_atomic_cmpswap_x2 v34, v[16:19], s[32:33] sc1
L_aux_nt:
  s_mov_b64 exec, -1
  s_mov_b32 s8, s80
  s_and_b32 s9, s81, 0xffff
  s_mov_b32 s10, 0x200000
  s_mov_b32 s11, 0x20000
  buffer_load_dwordx4 v[116:119], v10, s[8:11], 0 offen offset:0
  buffer_load_dwordx4 v[120:123], v10, s[8:11], 0 offen offset:128
  buffer_load_dwordx4 v[124:127], v10, s[8:11], 0 offen offset:256
  buffer_load_dwordx4 v[128:131], v10, s[8:11], 0 offen offset:384
  buffer_load_dwordx4 v[132:135], v10, s[8:11], 0 offen offset:512
  buffer_load_dwordx4 v[136:139], v10, s[8:11], 0 offen offset:640
  buffer_load_dwordx4 v[140:143], v10, s[8:11], 0 offen offset:768
  buffer_load_dwordx4 v[144:147], v10, s[8:11], 0 offen offset:896
  s_mov_b32 s16, s76
  s_and_b32 s17, s77, 0xffff
  s_mov_b32 s18, 0xc00000
  s_mov_b32 s19, 0x20000
  s_lshr_b32 s3, s2, 3
  s_lshl_b32 s3, s3, 16
  s_and_b32 s4, s2, 7
  s_lshl_b32 s5, s4, 7
  s_add_u32 s5, s5, s3
  v_lshrrev_b32 v9, 3, v1
  v_and_b32 v38, 7, v1
  v_lshlrev_b32 v2, 4, v38
  v_lshl_add_u32 v2, v9, 10, v2
  s_add_u32 s6, s5, 57344
  v_add_u32 v4, s6, v2
  s_lshl_b32 s6, s20, 14
  s_add_u32 s5, s5, s6
  v_add_u32 v3, s5, v2
  v_add_u32 v2, 0xffffe000, v3
  v_add_u32 v5, 7136, v3
  s_lshl_b32 s6, s20, 5
  s_add_u32 s6, s6, 141312
  v_mul_u32_u24 v36, 1056, v9
  v_lshl_add_u32 v36, v38, 2, v36
  v_add_u32 v36, s6, v36
  s_lshl_b32 s6, s4, 18
  s_lshl_b32 s7, s20, 16
  s_add_u32 s6, s6, s7
  s_lshr_b32 s7, s3, 9
  s_sub_u32 s6, s6, s7
  s_add_u32 s6, s6, 7344112
  v_lshlrev_b32 v37, 13, v38
  v_lshlrev_b32 v9, 4, v9
  v_sub_u32 v37, v37, v9
  v_add_u32 v37, s6, v37
  s_lshl_b32 s6, s4, 9
  s_lshl_b32 s7, s20, 7
  s_add_u32 s6, s6, s7
  v_lshl_add_u32 v38, v38, 4, s6
  s_lshl_b32 s6, s2, 7
  s_lshl_b32 s7, s20, 3
  s_add_u32 s6, s6, s7
  s_add_u32 s30, s6, 11567104
  s_mov_b32 s36, s82
  s_and_b32 s37, s83, 0xffff
  s_mov_b32 s38, 0x200000
  s_mov_b32 s39, 0x20000
  s_mov_b32 s44, s84
  s_and_b32 s45, s85, 0xffff
  s_mov_b32 s46, 0x200000
  s_mov_b32 s47, 0x20000
  s_mov_b32 s64, s86
  s_and_b32 s65, s87, 0xffff
  s_mov_b32 s66, 0x1000
  s_mov_b32 s67, 0x20000
  s_lshr_b32 s3, s20, 1
  s_lshl_b32 s4, s2, 1
  s_add_u32 s4, s4, s3
  s_mul_i32 s55, s3, 12928
  s_add_u32 s55, s55, 98304
  s_and_b32 s74, s20, 1
  s_lshl_b32 s75, s4, 12
  s_lshl_b32 s31, s4, 1
  s_lshl_b32 s77, s20, 12
  v_bfe_u32 v40, v1, 4, 1
  v_and_b32 v41, 15, v1
  v_add_u32 v42, v40, v41
  v_add_u32 v42, -16, v42
  v_lshlrev_b32 v248, 1, v42
  s_add_u32 s40, s60, s75
  s_addc_u32 s41, s61, 0
  s_and_b32 s41, s41, 0xffff
  s_sub_u32 s42, 0x200000, s75
  s_mov_b32 s43, 0x20000
  s_mov_b32 s80, s62
  s_and_b32 s81, s63, 0xffff
  s_mov_b32 s82, 0x400
  s_mov_b32 s83, 0x20000
  s_and_b32 s3, s2, 7
  s_lshr_b32 s4, s2, 3
  s_lshl_b32 s3, s3, 2
  s_and_b32 s5, s4, 3
  s_add_u32 s53, s3, s5
  s_lshr_b32 s54, s4, 2
  s_xor_b32 s54, s54, 3
  v_lshrrev_b32 v40, 4, v1
  v_and_b32 v41, 15, v1
  v_lshrrev_b32 v42, 3, v1
  v_and_b32 v43, 7, v1
  v_and_b32 v44, 1, v40
  v_lshlrev_b32 v44, 2, v44
  v_xor_b32 v44, v44, v43
  s_lshl_b32 s7, s54, 7
  s_mul_i32 s5, s20, 458752
  s_add_u32 s7, s7, s5
  v_lshlrev_b32 v44, 4, v44
  v_lshl_add_u32 v44, v42, 10, v44
  v_add_u32 v228, s7, v44
  v_add_u32 v229, 7168, v228
  v_add_u32 v230, 14336, v228
  v_add_u32 v231, 21504, v228
  s_lshr_b32 s5, s53, 2
  s_lshl_b32 s5, s5, 4
  s_and_b32 s6, s53, 3
  s_lshl_b32 s6, s6, 1
  s_add_u32 s6, s5, s6
  s_mul_i32 s5, s6, 57344
  s_mul_i32 s7, s20, 28672
  s_add_u32 s5, s5, s7
  v_add_u32 v232, s5, v31
  v_add_u32 v233, 458752, v232
  s_lshl_b32 s5, s6, 4
  s_lshl_b32 s7, s20, 3
  s_add_u32 s5, s5, s7
  v_lshrrev_b32 v44, 5, v1
  v_and_b32 v45, 3, v1
  v_lshl_add_u32 v44, v44, 2, v45
  v_add_u32 v44, s5, v44
  v_bfe_u32 v45, v1, 2, 3
  v_lshlrev_b32 v45, 4, v45
  v_lshl_add_u32 v45, v44, 10, v45
  s_lshl_b32 s7, s54, 7
  v_add_u32 v244, s7, v45
  v_lshlrev_b32 v44, 4, v44
  v_add_u32 v245, 11534336, v44
  v_bfe_u32 v42, v1, 2, 2
  v_lshrrev_b32 v43, 5, v1
  v_lshl_add_u32 v43, v43, 3, v42
  v_lshlrev_b32 v43, 7, v43
  v_lshrrev_b32 v42, 1, v42
  v_lshl_add_u32 v43, v42, 6, v43
  v_and_b32 v42, 1, v40
  v_lshl_add_u32 v43, v42, 5, v43
  v_and_b32 v42, 3, v1
  v_lshl_add_u32 v43, v42, 3, v43
  v_add_u32 v236, s77, v43
  v_xor_b32 v237, 64, v236
  v_add_u32 v42, 1, v41
  v_and_b32 v43, 1, v42
  v_sub_u32 v42, v42, v43
  v_lshl_add_u32 v42, v40, 3, v42
  v_lshlrev_b32 v42, 1, v42
  v_mul_u32_u24 v43, 4160, v43
  s_lshl_b32 s7, s74, 8
  s_add_u32 s7, s7, s55
  v_add3_u32 v240, v42, v43, s7
  v_lshlrev_b32 v42, 5, v41
  v_lshlrev_b32 v43, 4, v40
  v_sub_u32 v42, v43, v42
  s_add_u32 s7, s7, 8800
  v_add_u32 v241, s7, v42
  v_and_b32 v42, 1, v40
  v_mul_u32_u24 v42, 4160, v42
  v_lshl_add_u32 v42, v41, 1, v42
  v_add_u32 v249, s55, v42
  v_mov_b32 v46, 0
  v_mov_b32 v47, 0
  v_lshlrev_b32 v42, 3, v1
  s_add_u32 s7, s55, 12416
  v_add_u32 v42, s7, v42
  ds_write_b64 v42, v[46:47]
  v_and_b32 v42, 2, v40
  v_lshlrev_b32 v42, 3, v42
  v_and_b32 v43, 1, v41
  v_lshl_add_u32 v42, v43, 5, v42
  v_bfe_u32 v43, v41, 1, 2
  v_lshl_add_u32 v42, v43, 7, v42
  v_lshrrev_b32 v43, 3, v41
  v_lshl_add_u32 v42, v43, 6, v42
  v_and_b32 v43, 1, v40
  v_lshl_add_u32 v242, v43, 9, v42
  s_lshl_b32 s7, s74, 11
  s_add_u32 s7, s7, s75
  s_add_u32 s57, s7, 9437184
  s_lshl_b32 s7, s2, 13
  s_lshl_b32 s3, s20, 10
  s_add_u32 s7, s7, s3
  s_add_u32 s56, s7, 7340032
  s_lshl_b32 s7, s2, 7
  s_add_u32 s59, s7, 11632640
  v_and_b32 v42, 7, v1
  v_lshlrev_b32 v42, 7, v42
  s_lshl_b32 s7, s54, 12
  s_lshl_b32 s3, s20, 10
  s_add_u32 s7, s7, s3
  s_add_u32 s7, s7, 11632640
  v_add_u32 v243, s7, v42
  v_min_u32 v42, 6, v1
  v_lshlrev_b32 v42, 7, v42
  s_lshr_b32 s7, s53, 2
  s_lshl_b32 s7, s7, 5
  s_mul_i32 s3, s20, 7
  s_add_u32 s7, s7, s3
  s_lshl_b32 s7, s7, 7
  s_add_u32 s7, s7, 11599872
  v_add_u32 v246, s7, v42
  v_and_b32 v42, 7, v1
  v_lshlrev_b32 v42, 10, v42
  s_lshr_b32 s7, s2, 5
  s_lshl_b32 s7, s7, 7
  s_and_b32 s3, s2, 24
  s_add_u32 s7, s7, s3
  s_lshl_b32 s3, s20, 13
  s_sub_u32 s7, s7, s3
  s_add_u32 s7, s7, 11598848
  v_sub_u32 v247, s7, v42
  v_cmp_ne_u32 vcc, 0, v1
  v_mov_b32 v42, 0x80000000
  v_mov_b32 v43, 0
  v_cndmask_b32 v8, v43, v42, vcc
  buffer_load_dwordx4 v[148:151], v11, s[8:11], 0 offen offset:0
  buffer_load_dwordx4 v[152:155], v11, s[8:11], 0 offen offset:128
  buffer_load_dwordx4 v[156:159], v11, s[8:11], 0 offen offset:256
  buffer_load_dwordx4 v[160:163], v11, s[8:11], 0 offen offset:384
  buffer_load_dwordx4 v[164:167], v11, s[8:11], 0 offen offset:512
  buffer_load_dwordx4 v[168:171], v11, s[8:11], 0 offen offset:640
  buffer_load_dwordx4 v[172:175], v11, s[8:11], 0 offen offset:768
  buffer_load_dwordx4 v[176:179], v11, s[8:11], 0 offen offset:896
  global_load_dwordx2 v[32:33], v34, s[32:33] sc1
  s_mov_b32 s5, 0x3f803f80
  s_waitcnt vmcnt(9)
  v_dot2_f32_bf16 v16, v116, s5, 0
  v_dot2_f32_bf16 v17, v116, v116, 0
  v_dot2_f32_bf16 v18, v117, s5, 0
  v_dot2_f32_bf16 v19, v117, v117, 0
  v_dot2_f32_bf16 v16, v118, s5, v16
  v_dot2_f32_bf16 v17, v118, v118, v17
  v_dot2_f32_bf16 v18, v119, s5, v18
  v_dot2_f32_bf16 v19, v119, v119, v19
  v_dot2_f32_bf16 v16, v120, s5, v16
  v_dot2_f32_bf16 v17, v120, v120, v17
  v_dot2_f32_bf16 v18, v121, s5, v18
  v_dot2_f32_bf16 v19, v121, v121, v19
  v_dot2_f32_bf16 v16, v122, s5, v16
  v_dot2_f32_bf16 v17, v122, v122, v17
  v_dot2_f32_bf16 v18, v123, s5, v18
  v_dot2_f32_bf16 v19, v123, v123, v19
  v_dot2_f32_bf16 v16, v124, s5, v16
  v_dot2_f32_bf16 v17, v124, v124, v17
  v_dot2_f32_bf16 v18, v125, s5, v18
  v_dot2_f32_bf16 v19, v125, v125, v19
  v_dot2_f32_bf16 v16, v126, s5, v16
  v_dot2_f32_bf16 v17, v126, v126, v17
  v_dot2_f32_bf16 v18, v127, s5, v18
  v_dot2_f32_bf16 v19, v127, v127, v19
  v_dot2_f32_bf16 v16, v128, s5, v16
  v_dot2_f32_bf16 v17, v128, v128, v17
  v_dot2_f32_bf16 v18, v129, s5, v18
  v_dot2_f32_bf16 v19, v129, v129, v19
  v_dot2_f32_bf16 v16, v130, s5, v16
  v_dot2_f32_bf16 v17, v130, v130, v17
  v_dot2_f32_bf16 v18, v131, s5, v18
  v_dot2_f32_bf16 v19, v131, v131, v19
  v_dot2_f32_bf16 v16, v132, s5, v16
  v_dot2_f32_bf16 v17, v132, v132, v17
  v_dot2_f32_bf16 v18, v133, s5, v18
  v_dot2_f32_bf16 v19, v133, v133, v19
  v_dot2_f32_bf16 v16, v134, s5, v16
  v_dot2_f32_bf16 v17, v134, v134, v17
  v_dot2_f32_bf16 v18, v135, s5, v18
  v_dot2_f32_bf16 v19, v135, v135, v19
  v_dot2_f32_bf16 v16, v136, s5, v16
  v_dot2_f32_bf16 v17, v136, v136, v17
  v_dot2_f32_bf16 v18, v137, s5, v18
  v_dot2_f32_bf16 v19, v137, v137, v19
  v_dot2_f32_bf16 v16, v138, s5, v16
  v_dot2_f32_bf16 v17, v138, v138, v17
  v_dot2_f32_bf16 v18, v139, s5, v18
  v_dot2_f32_bf16 v19, v139, v139, v19
  v_dot2_f32_bf16 v16, v140, s5, v16
  v_dot2_f32_bf16 v17, v140, v140, v17
  v_dot2_f32_bf16 v18, v141, s5, v18
  v_dot2_f32_bf16 v19, v141, v141, v19
  v_dot2_f32_bf16 v16, v142, s5, v16
  v_dot2_f32_bf16 v17, v142, v142, v17
  v_dot2_f32_bf16 v18, v143, s5, v18
  v_dot2_f32_bf16 v19, v143, v143, v19
  v_dot2_f32_bf16 v16, v144, s5, v16
  v_dot2_f32_bf16 v17, v144, v144, v17
  v_dot2_f32_bf16 v18, v145, s5, v18
  v_dot2_f32_bf16 v19, v145, v145, v19
  v_dot2_f32_bf16 v16, v146, s5, v16
  v_dot2_f32_bf16 v17, v146, v146, v17
  v_dot2_f32_bf16 v18, v147, s5, v18
  v_dot2_f32_bf16 v19, v147, v147, v19
  s_waitcnt vmcnt(0)
  v_lshlrev_b32 v10, 7, v1
  s_mov_b32 s12, s60
  s_and_b32 s13, s61, 0xffff
  s_mov_b32 s14, 0x200000
  s_mov_b32 s15, 0x20000
  s_mov_b32 s24, s70
  s_and_b32 s25, s71, 0xffff
  s_mov_b32 s26, 1835008
  s_mov_b32 s27, 0x20000
  s_lshl_b32 s3, s2, 16
  s_lshl_b32 s4, s20, 14
  s_add_u32 s21, s3, s4
  s_mul_i32 s3, s2, 57344
  s_mul_i32 s4, s20, 14336
  s_add_u32 s22, s3, s4
  v_dot2_f32_bf16 v20, v148, s5, 0
  v_dot2_f32_bf16 v21, v148, v148, 0
  v_dot2_f32_bf16 v22, v149, s5, 0
  v_dot2_f32_bf16 v23, v149, v149, 0
  v_dot2_f32_bf16 v20, v150, s5, v20
  v_dot2_f32_bf16 v21, v150, v150, v21
  v_dot2_f32_bf16 v22, v151, s5, v22
  v_dot2_f32_bf16 v23, v151, v151, v23
  v_dot2_f32_bf16 v20, v152, s5, v20
  v_dot2_f32_bf16 v21, v152, v152, v21
  v_dot2_f32_bf16 v22, v153, s5, v22
  v_dot2_f32_bf16 v23, v153, v153, v23
  v_dot2_f32_bf16 v20, v154, s5, v20
  v_dot2_f32_bf16 v21, v154, v154, v21
  v_dot2_f32_bf16 v22, v155, s5, v22
  v_dot2_f32_bf16 v23, v155, v155, v23
  v_dot2_f32_bf16 v20, v156, s5, v20
  v_dot2_f32_bf16 v21, v156, v156, v21
  v_dot2_f32_bf16 v22, v157, s5, v22
  v_dot2_f32_bf16 v23, v157, v157, v23
  v_dot2_f32_bf16 v20, v158, s5, v20
  v_dot2_f32_bf16 v21, v158, v158, v21
  v_dot2_f32_bf16 v22, v159, s5, v22
  v_dot2_f32_bf16 v23, v159, v159, v23
  v_dot2_f32_bf16 v20, v160, s5, v20
  v_dot2_f32_bf16 v21, v160, v160, v21
  v_dot2_f32_bf16 v22, v161, s5, v22
  v_dot2_f32_bf16 v23, v161, v161, v23
  v_dot2_f32_bf16 v20, v162, s5, v20
  v_dot2_f32_bf16 v21, v162, v162, v21
  v_dot2_f32_bf16 v22, v163, s5, v22
  v_dot2_f32_bf16 v23, v163, v163, v23
  v_dot2_f32_bf16 v20, v164, s5, v20
  v_dot2_f32_bf16 v21, v164, v164, v21
  v_dot2_f32_bf16 v22, v165, s5, v22
  v_dot2_f32_bf16 v23, v165, v165, v23
  v_dot2_f32_bf16 v20, v166, s5, v20
  v_dot2_f32_bf16 v21, v166, v166, v21
  v_dot2_f32_bf16 v22, v167, s5, v22
  v_dot2_f32_bf16 v23, v167, v167, v23
  v_dot2_f32_bf16 v20, v168, s5, v20
  v_dot2_f32_bf16 v21, v168, v168, v21
  v_dot2_f32_bf16 v22, v169, s5, v22
  v_dot2_f32_bf16 v23, v169, v169, v23
  v_dot2_f32_bf16 v20, v170, s5, v20
  v_dot2_f32_bf16 v21, v170, v170, v21
  v_dot2_f32_bf16 v22, v171, s5, v22
  v_dot2_f32_bf16 v23, v171, v171, v23
  v_dot2_f32_bf16 v20, v172, s5, v20
  v_dot2_f32_bf16 v21, v172, v172, v21
  v_dot2_f32_bf16 v22, v173, s5, v22
  v_dot2_f32_bf16 v23, v173, v173, v23
  v_dot2_f32_bf16 v20, v174, s5, v20
  v_dot2_f32_bf16 v21, v174, v174, v21
  v_dot2_f32_bf16 v22, v175, s5, v22
  v_dot2_f32_bf16 v23, v175, v175, v23
  v_dot2_f32_bf16 v20, v176, s5, v20
  v_dot2_f32_bf16 v21, v176, v176, v21
  v_dot2_f32_bf16 v22, v177, s5, v22
  v_dot2_f32_bf16 v23, v177, v177, v23
  v_dot2_f32_bf16 v20, v178, s5, v20
  v_dot2_f32_bf16 v21, v178, v178, v21
  v_dot2_f32_bf16 v22, v179, s5, v22
  v_dot2_f32_bf16 v23, v179, v179, v23
  v_readfirstlane_b32 s48, v32
  v_readfirstlane_b32 s49, v33
  s_cmp_lg_u32 s48, 0
  s_cbranch_scc0 L_slow_na
L_ok_na:
  v_mov_b32 v6, v32
  v_mov_b32 v7, v33
  v_add_f32 v16, v16, v18
  v_add_f32 v17, v17, v19
  v_add_f32 v18, v20, v22
  v_add_f32 v19, v21, v23
  v_add_f32_dpp v16, v16, v16 quad_perm:[1,0,3,2] row_mask:0xf bank_mask:0xf
  v_add_f32_dpp v17, v17, v17 quad_perm:[1,0,3,2] row_mask:0xf bank_mask:0xf
  v_add_f32_dpp v18, v18, v18 quad_perm:[1,0,3,2] row_mask:0xf bank_mask:0xf
  v_add_f32_dpp v19, v19, v19 quad_perm:[1,0,3,2] row_mask:0xf bank_mask:0xf
  v_add_f32_dpp v16, v16, v16 quad_perm:[2,3,0,1] row_mask:0xf bank_mask:0xf
  v_add_f32_dpp v17, v17, v17 quad_perm:[2,3,0,1] row_mask:0xf bank_mask:0xf
  v_add_f32_dpp v18, v18, v18 quad_perm:[2,3,0,1] row_mask:0xf bank_mask:0xf
  v_add_f32_dpp v19, v19, v19 quad_perm:[2,3,0,1] row_mask:0xf bank_mask:0xf
  v_add_f32_dpp v16, v16, v16 row_half_mirror row_mask:0xf bank_mask:0xf
  v_add_f32_dpp v17, v17, v17 row_half_mirror row_mask:0xf bank_mask:0xf
  v_add_f32_dpp v18, v18, v18 row_half_mirror row_mask:0xf bank_mask:0xf
  v_add_f32_dpp v19, v19, v19 row_half_mirror row_mask:0xf bank_mask:0xf
  v_cmp_eq_u32 vcc, 0, v13
  v_lshlrev_b32 v12, 4, v12
  v_add_u32 v12, 11534336, v12
  v_mov_b32 v14, 0x80000000
  v_cndmask_b32 v12, v14, v12, vcc
  v_mul_f32 v16, 0x3b000000, v16
  v_mul_f32 v18, 0x3b000000, v18
  v_mul_f32 v17, 0x3b000000, v17
  v_mul_f32 v19, 0x3b000000, v19
  v_fma_f32 v17, -v16, v16, v17
  v_fma_f32 v19, -v18, v18, v19
  v_max_f32 v17, 0, v17
  v_max_f32 v19, 0, v19
  v_cvt_pk_bf16_f32 v17, v17, v17
  v_cvt_pk_bf16_f32 v19, v19, v19
  v_and_b32 v17, 0xffff0000, v17
  v_and_b32 v19, 0xffff0000, v19
  v_add_f32 v17, 0x3727c5ac, v17
  v_add_f32 v19, 0x3727c5ac, v19
  v_cvt_pk_bf16_f32 v17, v17, v17
  v_cvt_pk_bf16_f32 v19, v19, v19
  v_and_b32 v17, 0xffff0000, v17
  v_and_b32 v19, 0xffff0000, v19
  v_sqrt_f32 v17, v17
  v_sqrt_f32 v19, v19
  v_cvt_pk_bf16_f32 v20, -v16, -v16
  v_cvt_pk_bf16_f32 v24, -v18, -v18
  v_cvt_pk_bf16_f32 v17, v17, v17
  v_cvt_pk_bf16_f32 v19, v19, v19
  v_and_b32 v17, 0xffff0000, v17
  v_and_b32 v19, 0xffff0000, v19
  v_rcp_f32 v22, v17
  v_rcp_f32 v26, v19
  v_mul_f32 v21, 0xbfb8aa3b, v17
  v_mul_f32 v25, 0xbfb8aa3b, v19
  v_mul_f32 v22, 0xbfb8aa3b, v22
  v_mul_f32 v26, 0xbfb8aa3b, v26
  v_mov_b32 v23, s48
  v_mov_b32 v27, s48
  buffer_store_dwordx4 v[20:23], v12, s[16:19], 0 offen sc1
  buffer_store_dwordx4 v[24:27], v12, s[16:19], 0 offen offset:128 sc1
  s_barrier
  s_mul_i32 s52, s20, 2112
  s_add_u32 s52, s52, 141312
  s_mov_b32 m0, s52
  s_nop 0
  buffer_load_dwordx4 v2, s[36:39], 0 offen offset:0 lds
  s_add_u32 m0, s52, 1056
  s_nop 0
  buffer_load_dwordx4 v3, s[36:39], 0 offen offset:0 lds
  s_mov_b32 m0, 149760
  s_nop 0
  buffer_load_dwordx4 v4, s[36:39], 0 offen offset:0 lds
  s_add_u32 m0, s52, 9504
  s_nop 0
  buffer_load_dwordx4 v3, s[44:47], 0 offen offset:0 lds
  buffer_load_dwordx4 v5, s[44:47], 0 offen offset:1056 lds
  buffer_load_dwordx4 v[72:75], v38, s[64:67], 0 offen
  s_lshl_b32 s6, s74, 11
  s_add_u32 m0, s6, s55
  s_add_u32 m0, m0, 32
  s_nop 0
  buffer_load_dwordx4 v31, s[40:43], s6 offen offset:0 lds
  buffer_load_dwordx4 v31, s[40:43], s6 offen offset:1024 lds
  buffer_load_ushort v248, v248, s[40:43], 0 offen
  buffer_load_ushort v254, off, s[80:83], s31
  s_mov_b32 s36, s70
  s_and_b32 s37, s71, 0xffff
  s_mov_b32 s38, 0x1c0000
  s_mov_b32 s39, 0x20000
  s_mov_b32 s44, s72
  s_and_b32 s45, s73, 0xffff
  s_mov_b32 s46, 0x200000
  s_mov_b32 s47, 0x20000
  s_mov_b32 s60, 0
  s_mov_b32 s61, 32768
  s_mov_b32 s62, 65536
  s_mov_b32 s63, 98304
  s_mov_b32 s64, 131072
  s_mov_b32 s65, 163840
  s_mov_b32 s66, 196608
  s_mov_b32 s67, 229376
  s_mov_b32 s68, 262144
  s_mov_b32 s69, 294912
  s_mov_b32 s70, 327680
  s_mov_b32 s71, 360448
  s_mov_b32 s72, 393216
  s_mov_b32 s73, 425984
  s_waitcnt vmcnt(0)
  s_barrier
  buffer_load_dword v28, v10, s[24:27], s22 offen
  s_add_u32 s22, s22, 6144
  ds_read_b32 v52, v36 offset:640
  ds_read_b32 v53, v36 offset:768
  ds_read_b32 v54, v36 offset:896
  ds_read_b32 v55, v36 offset:1056
  ds_read_b32 v56, v36 offset:1184
  ds_read_b32 v57, v36 offset:1312
  ds_read_b32 v58, v36 offset:1440
  ds_read_b32 v59, v36 offset:1568
  ds_read_b32 v60, v36 offset:1696
  ds_read_b32 v61, v36 offset:1824
  ds_read_b32 v62, v36 offset:1952
  ds_read_b32 v63, v36 offset:9504
  ds_read_b32 v64, v36 offset:9632
  ds_read_b32 v65, v36 offset:9760
  ds_read_b32 v66, v36 offset:9888
  ds_read_b32 v67, v36 offset:10016
  ds_read_b32 v68, v36 offset:10144
  ds_read_b32 v69, v36 offset:10272
  ds_read_b32 v70, v36 offset:10400
  v_lshlrev_b32 v76, 16, v72
  v_and_b32 v77, 0xffff0000, v72
  v_lshlrev_b32 v78, 16, v73
  v_and_b32 v79, 0xffff0000, v73
  v_lshlrev_b32 v80, 16, v74
  v_and_b32 v81, 0xffff0000, v74
  v_lshlrev_b32 v82, 16, v75
  v_and_b32 v83, 0xffff0000, v75
  s_waitcnt lgkmcnt(0)
  v_lshlrev_b32 v212, 16, v52
  v_lshlrev_b32 v213, 16, v53
  v_lshlrev_b32 v214, 16, v54
  v_lshlrev_b32 v215, 16, v55
  v_lshlrev_b32 v216, 16, v56
  v_lshlrev_b32 v217, 16, v57
  v_lshlrev_b32 v218, 16, v58
  v_lshlrev_b32 v219, 16, v59
  v_lshlrev_b32 v220, 16, v60
  v_lshlrev_b32 v221, 16, v61
  v_lshlrev_b32 v222, 16, v62
  v_mul_f32 v223, v212, v79
  v_lshlrev_b32 v225, 16, v63
  v_fmac_f32 v223, v213, v78
  v_fmac_f32 v223, v214, v77
  v_fmac_f32 v223, v215, v76
  v_mul_f32 v223, v223, v225
  v_mul_f32 v224, v213, v79
  v_lshlrev_b32 v225, 16, v64
  v_fmac_f32 v224, v214, v78
  v_fmac_f32 v224, v215, v77
  v_fmac_f32 v224, v216, v76
  v_mul_f32 v224, v224, v225
  v_cvt_pk_bf16_f32 v35, v224, v223
  v_mul_f32 v223, v214, v79
  v_lshlrev_b32 v225, 16, v65
  v_fmac_f32 v223, v215, v78
  v_fmac_f32 v223, v216, v77
  v_fmac_f32 v223, v217, v76
  v_mul_f32 v223, v223, v225
  v_mul_f32 v224, v215, v79
  v_lshlrev_b32 v225, 16, v66
  v_fmac_f32 v224, v216, v78
  v_fmac_f32 v224, v217, v77
  v_fmac_f32 v224, v218, v76
  v_mul_f32 v224, v224, v225
  v_cvt_pk_bf16_f32 v34, v224, v223
  v_mul_f32 v223, v216, v79
  v_lshlrev_b32 v225, 16, v67
  v_fmac_f32 v223, v217, v78
  v_fmac_f32 v223, v218, v77
  v_fmac_f32 v223, v219, v76
  v_mul_f32 v223, v223, v225
  v_mul_f32 v224, v217, v79
  v_lshlrev_b32 v225, 16, v68
  v_fmac_f32 v224, v218, v78
  v_fmac_f32 v224, v219, v77
  v_fmac_f32 v224, v220, v76
  v_mul_f32 v224, v224, v225
  v_cvt_pk_bf16_f32 v33, v224, v223
  v_mul_f32 v223, v218, v79
  v_lshlrev_b32 v225, 16, v69
  v_fmac_f32 v223, v219, v78
  v_fmac_f32 v223, v220, v77
  v_fmac_f32 v223, v221, v76
  v_mul_f32 v223, v223, v225
  v_mul_f32 v224, v219, v79
  v_lshlrev_b32 v225, 16, v70
  v_fmac_f32 v224, v220, v78
  v_fmac_f32 v224, v221, v77
  v_fmac_f32 v224, v222, v76
  v_mul_f32 v224, v224, v225
  v_cvt_pk_bf16_f32 v32, v224, v223
  v_and_b32 v212, 0xffff0000, v52
  v_and_b32 v213, 0xffff0000, v53
  v_and_b32 v214, 0xffff0000, v54
  v_and_b32 v215, 0xffff0000, v55
  v_and_b32 v216, 0xffff0000, v56
  v_and_b32 v217, 0xffff0000, v57
  v_and_b32 v218, 0xffff0000, v58
  v_and_b32 v219, 0xffff0000, v59
  v_and_b32 v220, 0xffff0000, v60
  v_and_b32 v221, 0xffff0000, v61
  v_and_b32 v222, 0xffff0000, v62
  v_mul_f32 v223, v212, v83
  v_and_b32 v225, 0xffff0000, v63
  v_fmac_f32 v223, v213, v82
  v_fmac_f32 v223, v214, v81
  v_fmac_f32 v223, v215, v80
  v_mul_f32 v223, v223, v225
  v_mul_f32 v224, v213, v83
  v_and_b32 v225, 0xffff0000, v64
  v_fmac_f32 v224, v214, v82
  v_fmac_f32 v224, v215, v81
  v_fmac_f32 v224, v216, v80
  v_mul_f32 v224, v224, v225
  v_cvt_pk_bf16_f32 v253, v224, v223
  v_mul_f32 v223, v214, v83
  v_and_b32 v225, 0xffff0000, v65
  v_fmac_f32 v223, v215, v82
  v_fmac_f32 v223, v216, v81
  v_fmac_f32 v223, v217, v80
  v_mul_f32 v223, v223, v225
  v_mul_f32 v224, v215, v83
  v_and_b32 v225, 0xffff0000, v66
  v_fmac_f32 v224, v216, v82
  v_fmac_f32 v224, v217, v81
  v_fmac_f32 v224, v218, v80
  v_mul_f32 v224, v224, v225
  v_cvt_pk_bf16_f32 v252, v224, v223
  v_mul_f32 v223, v216, v83
  v_and_b32 v225, 0xffff0000, v67
  v_fmac_f32 v223, v217, v82
  v_fmac_f32 v223, v218, v81
  v_fmac_f32 v223, v219, v80
  v_mul_f32 v223, v223, v225
  v_mul_f32 v224, v217, v83
  v_and_b32 v225, 0xffff0000, v68
  v_fmac_f32 v224, v218, v82
  v_fmac_f32 v224, v219, v81
  v_fmac_f32 v224, v220, v80
  v_mul_f32 v224, v224, v225
  v_cvt_pk_bf16_f32 v251, v224, v223
  v_mul_f32 v223, v218, v83
  v_and_b32 v225, 0xffff0000, v69
  v_fmac_f32 v223, v219, v82
  v_fmac_f32 v223, v220, v81
  v_fmac_f32 v223, v221, v80
  v_mul_f32 v223, v223, v225
  v_mul_f32 v224, v219, v83
  v_and_b32 v225, 0xffff0000, v70
  v_fmac_f32 v224, v220, v82
  v_fmac_f32 v224, v221, v81
  v_fmac_f32 v224, v222, v80
  v_mul_f32 v224, v224, v225
  v_cvt_pk_bf16_f32 v250, v224, v223
  s_mov_b32 s34, 4096
  buffer_store_dwordx4 v[32:35], v37, s[16:19], 0 offen sc1
  buffer_store_dwordx4 v[250:253], v37, s[16:19], s34 offen sc1
  s_lshl_b32 s5, s74, 11
  s_add_u32 s5, s5, s55
  v_add_u32 v39, s5, v31
  ds_write_b16 v249, v248
  ds_read_b128 v[212:215], v39 offset:32
  ds_read_b32 v216, v39 offset:48
  s_waitcnt lgkmcnt(0)
  v_alignbit_b32 v220, v213, v212, 16
  v_alignbit_b32 v221, v214, v213, 16
  v_alignbit_b32 v222, v215, v214, 16
  v_alignbit_b32 v223, v216, v215, 16
  ds_write_b128 v39, v[220:223] offset:4192
  ds_read_b128 v[212:215], v39 offset:1056
  ds_read_b32 v216, v39 offset:1072
  s_waitcnt lgkmcnt(0)
  v_alignbit_b32 v220, v213, v212, 16
  v_alignbit_b32 v221, v214, v213, 16
  v_alignbit_b32 v222, v215, v214, 16
  v_alignbit_b32 v223, v216, v215, 16
  ds_write_b128 v39, v[220:223] offset:5216
  buffer_load_dword v28, v10, s[24:27], s22 offen
  s_waitcnt vmcnt(1) lgkmcnt(0)
  buffer_store_dwordx2 v[6:7], v8, s[16:19], s30 offen sc1
  buffer_load_dword v28, v10, s[12:15], s21 offen
  s_add_u32 s21, s21, 8192
  buffer_load_dword v28, v10, s[12:15], s21 offen
  s_lshl_b32 s3, s2, 7
  s_add_u32 s58, s3, 11665408
  s_lshl_b32 s6, s20, 31
  s_lshl_b32 s7, s20, 30
  s_or_b32 s6, s6, s7
  s_and_b32 s6, s6, 0x80000000
  v_or_b32 v9, s6, v8
  s_barrier
  v_add_u32 v2, 0x20000, v236
  v_add_u32 v3, 0x20000, v237
  s_add_u32 m0, s77, 141312
  s_nop 0
  buffer_load_dwordx4 v228, s[36:39], s60 offen offset:0 lds
  buffer_load_dwordx4 v229, s[36:39], s60 offen offset:1024 lds
  buffer_load_dwordx4 v230, s[36:39], s60 offen offset:2048 lds
  buffer_load_dwordx4 v231, s[36:39], s60 offen offset:3072 lds
  s_add_u32 m0, s77, 0
  s_nop 0
  buffer_load_dwordx4 v228, s[36:39], s61 offen offset:0 lds
  buffer_load_dwordx4 v229, s[36:39], s61 offen offset:1024 lds
  buffer_load_dwordx4 v230, s[36:39], s61 offen offset:2048 lds
  buffer_load_dwordx4 v231, s[36:39], s61 offen offset:3072 lds
  s_add_u32 m0, s77, 16384
  s_nop 0
  buffer_load_dwordx4 v228, s[36:39], s62 offen offset:0 lds
  buffer_load_dwordx4 v229, s[36:39], s62 offen offset:1024 lds
  buffer_load_dwordx4 v230, s[36:39], s62 offen offset:2048 lds
  buffer_load_dwordx4 v231, s[36:39], s62 offen offset:3072 lds
  s_add_u32 m0, s77, 32768
  s_nop 0
  buffer_load_dwordx4 v228, s[36:39], s63 offen offset:0 lds
  buffer_load_dwordx4 v229, s[36:39], s63 offen offset:1024 lds
  buffer_load_dwordx4 v230, s[36:39], s63 offen offset:2048 lds
  buffer_load_dwordx4 v231, s[36:39], s63 offen offset:3072 lds
  s_add_u32 m0, s77, 49152
  s_nop 0
  buffer_load_dwordx4 v228, s[36:39], s64 offen offset:0 lds
  buffer_load_dwordx4 v229, s[36:39], s64 offen offset:1024 lds
  buffer_load_dwordx4 v230, s[36:39], s64 offen offset:2048 lds
  buffer_load_dwordx4 v231, s[36:39], s64 offen offset:3072 lds
  s_add_u32 m0, s77, 124416
  s_nop 0
  buffer_load_dwordx4 v228, s[36:39], s65 offen offset:0 lds
  buffer_load_dwordx4 v229, s[36:39], s65 offen offset:1024 lds
  buffer_load_dwordx4 v230, s[36:39], s65 offen offset:2048 lds
  buffer_load_dwordx4 v231, s[36:39], s65 offen offset:3072 lds
  s_add_u32 m0, s77, 81920
  s_nop 0
  buffer_load_dwordx4 v228, s[36:39], s66 offen offset:0 lds
  buffer_load_dwordx4 v229, s[36:39], s66 offen offset:1024 lds
  buffer_load_dwordx4 v230, s[36:39], s66 offen offset:2048 lds
  buffer_load_dwordx4 v231, s[36:39], s66 offen offset:3072 lds
  s_waitcnt vmcnt(24)
  ds_read_b64_tr_b16 a[128:129], v2 offset:10240
  ds_read_b64_tr_b16 a[130:131], v2 offset:10752
  ds_read_b64_tr_b16 a[132:133], v3 offset:10240
  ds_read_b64_tr_b16 a[134:135], v3 offset:10752
  ds_read_b64_tr_b16 a[136:137], v2 offset:12288
  ds_read_b64_tr_b16 a[138:139], v2 offset:12800
  ds_read_b64_tr_b16 a[140:141], v3 offset:12288
  ds_read_b64_tr_b16 a[142:143], v3 offset:12800
  s_waitcnt lgkmcnt(0)
  s_add_u32 m0, s77, 141312
  s_nop 0
  buffer_load_dwordx4 v228, s[36:39], s67 offen offset:0 lds
  buffer_load_dwordx4 v229, s[36:39], s67 offen offset:1024 lds
  buffer_load_dwordx4 v230, s[36:39], s67 offen offset:2048 lds
  buffer_load_dwordx4 v231, s[36:39], s67 offen offset:3072 lds
  s_add_u32 m0, s77, 65536
  s_nop 0
  buffer_load_dwordx4 v228, s[36:39], s72 offen offset:0 lds
  buffer_load_dwordx4 v229, s[36:39], s72 offen offset:1024 lds
  buffer_load_dwordx4 v230, s[36:39], s72 offen offset:2048 lds
  buffer_load_dwordx4 v231, s[36:39], s72 offen offset:3072 lds
  s_mov_b32 s84, 0
  s_mov_b32 s85, 4096
  s_mov_b32 s86, 8192
  s_mov_b32 s87, 12288
  s_mov_b32 s88, 16384
  s_mov_b32 s89, 20480
  s_mov_b32 s90, 24576
  buffer_load_dwordx2 v[250:251], v247, s[16:19], 0 offen sc1
  s_waitcnt vmcnt(0)
  v_cmp_ne_u64 vcc, s[48:49], v[250:251]
  s_cbranch_vccnz L_slow_kva
L_ok_kva:
  s_lshl_b32 s7, s20, 10
  s_add_u32 m0, s7, 106624
  s_nop 0
  buffer_load_dwordx4 v31, s[16:19], s56 offen offset:0 sc1 lds
  s_add_u32 s56, s56, 4096
  s_add_u32 m0, s7, 119552
  s_nop 0
  buffer_load_dwordx4 v31, s[16:19], s56 offen offset:0 sc1 lds
  s_waitcnt vmcnt(0)
  v_add_u32 v10, 1024, v240
  v_add_u32 v11, 2048, v240
  v_add_u32 v12, 3072, v240
  s_waitcnt lgkmcnt(0)
  s_barrier
  ds_read2_b32 v[148:149], v240 offset0:0 offset1:1
  ds_read2_b32 v[150:151], v240 offset0:2 offset1:3
  ds_read_b128 v[180:183], v241 offset:3584
  ds_read2_b32 v[152:153], v240 offset0:128 offset1:129
  ds_read2_b32 v[154:155], v240 offset0:130 offset1:131
  ds_read_b128 v[184:187], v241 offset:3072
  ds_read2_b32 v[156:157], v10 offset0:0 offset1:1
  ds_read2_b32 v[158:159], v10 offset0:2 offset1:3
  ds_read_b128 v[188:191], v241 offset:2560
  ds_read2_b32 v[160:161], v10 offset0:128 offset1:129
  ds_read2_b32 v[162:163], v10 offset0:130 offset1:131
  ds_read_b128 v[192:195], v241 offset:2048
  ds_read2_b32 v[164:165], v11 offset0:0 offset1:1
  ds_read2_b32 v[166:167], v11 offset0:2 offset1:3
  ds_read_b128 v[196:199], v241 offset:1536
  ds_read2_b32 v[168:169], v11 offset0:128 offset1:129
  ds_read2_b32 v[170:171], v11 offset0:130 offset1:131
  ds_read_b128 v[200:203], v241 offset:1024
  ds_read2_b32 v[172:173], v12 offset0:0 offset1:1
  ds_read2_b32 v[174:175], v12 offset0:2 offset1:3
  ds_read_b128 v[204:207], v241 offset:512
  ds_read2_b32 v[176:177], v12 offset0:128 offset1:129
  ds_read2_b32 v[178:179], v12 offset0:130 offset1:131
  ds_read_b128 v[208:211], v241 offset:0
s_branch L_phase2
L_slow_ng:
s_mov_b32 s76, 1
L_spin_ng:
s_sleep 4
global_load_dwordx2 v[32:33], v34, s[32:33] sc1
s_waitcnt vmcnt(0)
v_readfirstlane_b32 s48, v32
v_readfirstlane_b32 s49, v33
s_cmp_lg_u32 s48, 0
s_cbranch_scc1 L_ok_ng
s_add_u32 s76, s76, 1
s_cmp_lt_u32 s76, 2097152
s_cbranch_scc1 L_spin_ng
s_branch L_ok_ng
L_slow_rec:
s_mov_b32 s76, 1
L_spin_rec:
s_sleep 2
buffer_load_dwordx4 v[52:55], v29, s[16:19], s29 offen offset:0 sc1
buffer_load_dwordx4 v[56:59], v29, s[16:19], s29 offen offset:512 sc1
buffer_load_dwordx4 v[60:63], v29, s[16:19], s29 offen offset:1024 sc1
buffer_load_dwordx4 v[64:67], v29, s[16:19], s29 offen offset:1536 sc1
buffer_load_dwordx4 v[68:71], v29, s[16:19], s29 offen offset:2048 sc1
buffer_load_dwordx4 v[72:75], v29, s[16:19], s29 offen offset:2560 sc1
buffer_load_dwordx4 v[76:79], v29, s[16:19], s29 offen offset:3072 sc1
buffer_load_dwordx4 v[80:83], v29, s[16:19], s29 offen offset:3584 sc1
s_waitcnt vmcnt(0)
v_cmp_ne_u32 vcc, s48, v55
v_cmp_ne_u32 s[4:5], s48, v59
s_or_b64 vcc, vcc, s[4:5]
v_cmp_ne_u32 s[4:5], s48, v63
s_or_b64 vcc, vcc, s[4:5]
v_cmp_ne_u32 s[4:5], s48, v67
s_or_b64 vcc, vcc, s[4:5]
v_cmp_ne_u32 s[4:5], s48, v71
s_or_b64 vcc, vcc, s[4:5]
v_cmp_ne_u32 s[4:5], s48, v75
s_or_b64 vcc, vcc, s[4:5]
v_cmp_ne_u32 s[4:5], s48, v79
s_or_b64 vcc, vcc, s[4:5]
v_cmp_ne_u32 s[4:5], s48, v83
s_or_b64 vcc, vcc, s[4:5]
s_cbranch_vccz L_ok_rec
s_add_u32 s76, s76, 1
s_cmp_lt_u32 s76, 2097152
s_cbranch_scc1 L_spin_rec
s_branch L_ok_rec
L_slow_kv:
s_mov_b32 s76, 1
L_spin_kv:
s_sleep 2
buffer_load_dwordx2 v[250:251], v247, s[16:19], 0 offen sc1
s_waitcnt vmcnt(0)
v_cmp_ne_u64 vcc, s[48:49], v[250:251]
s_cbranch_vccz L_ok_kv
s_add_u32 s76, s76, 1
s_cmp_lt_u32 s76, 2097152
s_cbranch_scc1 L_spin_kv
s_branch L_ok_kv
L_slow_st:
s_mov_b32 s76, 1
L_spin_st:
s_sleep 2
buffer_load_dwordx4 v[40:43], v245, s[16:19], 0 offen offset:0 sc1
buffer_load_dwordx4 v[224:227], v245, s[16:19], 0 offen offset:2048 sc1
s_waitcnt vmcnt(0)
v_cmp_ne_u32 vcc, s48, v43
v_cmp_ne_u32 s[4:5], s48, v227
s_or_b64 vcc, vcc, s[4:5]
s_cbranch_vccz L_ok_st
s_add_u32 s76, s76, 1
s_cmp_lt_u32 s76, 2097152
s_cbranch_scc1 L_spin_st
s_branch L_ok_st
L_slow_hA:
s_mov_b32 s76, 1
L_spin_hA:
s_sleep 2
buffer_load_dwordx2 v[250:251], v246, s[16:19], 0 offen sc1
s_waitcnt vmcnt(0)
v_cmp_ne_u64 vcc, s[48:49], v[250:251]
s_cbranch_vccz L_ok_hA
s_add_u32 s76, s76, 1
s_cmp_lt_u32 s76, 2097152
s_cbranch_scc1 L_spin_hA
s_branch L_ok_hA
L_slow_hB:
s_mov_b32 s76, 1
L_spin_hB:
s_sleep 2
s_mov_b32 s27, 131072
buffer_load_dwordx2 v[252:253], v246, s[16:19], s27 offen sc1
s_waitcnt vmcnt(0)
v_cmp_ne_u64 vcc, s[48:49], v[252:253]
s_cbranch_vccz L_ok_hB
s_add_u32 s76, s76, 1
s_cmp_lt_u32 s76, 2097152
s_cbranch_scc1 L_spin_hB
s_branch L_ok_hB
L_slow_y:
s_mov_b32 s76, 1
L_spin_y:
s_sleep 2
buffer_load_dwordx2 v[250:251], v243, s[16:19], 0 offen sc1
s_waitcnt vmcnt(0)
v_cmp_ne_u64 vcc, s[48:49], v[250:251]
s_cbranch_vccz L_ok_y
s_add_u32 s76, s76, 1
s_cmp_lt_u32 s76, 2097152
s_cbranch_scc1 L_spin_y
s_branch L_ok_y
L_slow_na:
s_mov_b32 s76, 1
L_spin_na:
s_sleep 4
global_load_dwordx2 v[32:33], v34, s[32:33] sc1
s_waitcnt vmcnt(0)
v_readfirstlane_b32 s48, v32
v_readfirstlane_b32 s49, v33
s_cmp_lg_u32 s48, 0
s_cbranch_scc1 L_ok_na
s_add_u32 s76, s76, 1
s_cmp_lt_u32 s76, 2097152
s_cbranch_scc1 L_spin_na
s_branch L_ok_na
L_slow_kva:
s_mov_b32 s76, 1
L_spin_kva:
s_sleep 16
buffer_load_dwordx2 v[250:251], v247, s[16:19], 0 offen sc1
s_waitcnt vmcnt(0)
v_cmp_ne_u64 vcc, s[48:49], v[250:251]
s_cbranch_vccz L_ok_kva
s_add_u32 s76, s76, 1
s_cmp_lt_u32 s76, 2097152
s_cbranch_scc1 L_spin_kva
s_branch L_ok_kva
L_code_end:
.section .rodata,"a"
.p2align 6

.amdhsa_kernel recurrent_scan__ssm_conv_h3__swiglu_ffn__prompt_kernel
  .amdhsa_next_free_vgpr 512
  .amdhsa_next_free_sgpr 102
  .amdhsa_accum_offset 256
  .amdhsa_group_segment_fixed_size 0
  .amdhsa_kernarg_size 104
  .amdhsa_user_sgpr_count 2
  .amdhsa_user_sgpr_kernarg_segment_ptr 1
  .amdhsa_system_sgpr_workgroup_id_x 1
.end_amdhsa_kernel
```
